```python
import torch

def _softmax(x, axis=-1):
    return torch.softmax(x, dim=axis)
def _gelu(x):
    return torch.nn.functional.gelu(x, approximate="tanh")
def _silu(x):
    return torch.nn.functional.silu(x)
def _sigmoid(x):
    return torch.sigmoid(x)
def _layernorm(x, axis=-1, eps=1e-5):
    m = x.mean(dim=axis, keepdim=True)
    v = x.var(dim=axis, keepdim=True, unbiased=False)
    return (x - m) / torch.sqrt(v + eps)
def _scatter_add(tgt, idx, src, axis=0):
    return tgt.clone().index_add_(axis, idx, src)
def _segment_sum(src, seg, n):
    out = torch.zeros((n,) + src.shape[1:], dtype=src.dtype)
    return out.index_add_(0, seg, src)
def _pad(x, pw):
    flat = tuple(v for pair in reversed(pw) for v in pair)
    return torch.nn.functional.pad(x, flat)

kernel_name = 'sequential_preLN__ssm_conv_s4d__geglu_ffn__prompt'

def setup_inputs():

    _w = (lambda a: (lambda t: t.to(torch.bfloat16) if t.is_floating_point() else t)(torch.as_tensor(a)))
    def _A_setup():
        Bsz, L, D, N = 1, 2048, 448, 256
        return {
            "u": _w((lambda *s: torch.randn(*s, dtype=torch.bfloat16) * 0.05)(Bsz, L, D)),
            "log_A_real": _w((lambda *s: torch.randn(*s, dtype=torch.bfloat16) * 6.4)(D, N) * 0.5),
            "A_imag": _w((lambda *s: torch.randn(*s, dtype=torch.bfloat16) * 0.05)(D, N) * 3.14),
            "C_real": _w((lambda *s: torch.randn(*s, dtype=torch.bfloat16) * 0.05)(D, N) / N ** 0.5),
            "C_imag": _w((lambda *s: torch.randn(*s, dtype=torch.bfloat16) * 0.05)(D, N) / N ** 0.5),
            "log_dt": _w((lambda *s: torch.randn(*s, dtype=torch.bfloat16) * 0.05)(D) * 0.5 - 4.0),
            "D_skip": _w((lambda *s: torch.randn(*s, dtype=torch.bfloat16) * 0.05)(D)),
        }
    _A_in = _A_setup()

    def _B_setup():
        B, S, D, F = 1, 2048, 448, 1792
        return {
            "x": _w((lambda *s: torch.randn(*s, dtype=torch.bfloat16) * 0.05)(B, S, D)),
            "w_gate": _w((lambda *s: torch.randn(*s, dtype=torch.bfloat16) * 0.05)(D, F)),
            "w_up": _w((lambda *s: torch.randn(*s, dtype=torch.bfloat16) * 0.05)(D, F)),
            "w_down": _w((lambda *s: torch.randn(*s, dtype=torch.bfloat16) * 0.05)(F, D)),
        }
    _B_in = _B_setup()

    return {
        "A_u": _A_in["u"],
        "A_log_A_real": _A_in["log_A_real"],
        "A_A_imag": _A_in["A_imag"],
        "A_C_real": _A_in["C_real"],
        "A_C_imag": _A_in["C_imag"],
        "A_log_dt": _A_in["log_dt"],
        "A_D_skip": _A_in["D_skip"],
        "B_x": _B_in["x"],
        "B_w_gate": _B_in["w_gate"],
        "B_w_up": _B_in["w_up"],
        "B_w_down": _B_in["w_down"],
    }

def reference(A_u, A_log_A_real, A_A_imag, A_C_real, A_C_imag, A_log_dt, A_D_skip, B_x, B_w_gate, B_w_up, B_w_down):
    def _A_ref(u, log_A_real, A_imag, C_real, C_imag, log_dt, D_skip):
        L = u.shape[1]
        dt = torch.exp(log_dt)
        A = -torch.exp(log_A_real) + 1j * A_imag
        C = (C_real + 1j * C_imag) * dt[:, None]
        pos = (lambda x, dt: x.to(dt))(torch.arange(L), log_dt.dtype)
        P = torch.exp((A * dt[:, None])[:, :, None] * pos[None, None, :])
        K = 2.0 * torch.einsum("dn,dnl->dl", C, P).real
        L2 = 2 * L
        u_t = (lambda x, *d: x.permute(*d))(u, 0, 2, 1)
        Kf = (lambda x, *a, **k: torch.fft.rfft(x.float(), *a, **k))(K, L2)
        Uf = (lambda x, *a, **k: torch.fft.rfft(x.float(), *a, **k))(u_t, L2)
        y = (lambda x, *a, **k: torch.fft.irfft(x, *a, **k).to(torch.bfloat16))(Uf * Kf[None, :, :], L2)[:, :, :L]
        y = (lambda x, *d: x.permute(*d))(y, 0, 2, 1)
        return y + u * D_skip[None, None, :]

    def _B_ref(x, w_gate, w_up, w_down):
        return (_gelu(x @ w_gate) * (x @ w_up)) @ w_down

    x = A_u
    h = x + _A_ref(_layernorm(x, axis=-1), A_log_A_real, A_A_imag, A_C_real, A_C_imag, A_log_dt, A_D_skip)
    h2 = h + _B_ref(_layernorm(h, axis=-1), B_w_gate, B_w_up, B_w_down)
    return h2
```

```asm
; @launch grid=(256,1,1) block=(256,1,1) lds=163840
.amdgcn_target "amdgcn-amd-amdhsa--gfx950"
.text
.globl sequential_preLN__ssm_conv_s4d__geglu_ffn__prompt_kernel
.p2align 12
.p2align 8
.type sequential_preLN__ssm_conv_s4d__geglu_ffn__prompt_kernel,@function
sequential_preLN__ssm_conv_s4d__geglu_ffn__prompt_kernel:
    s_cmp_ge_u32 s2, 256
    s_cbranch_scc1 L_end
    s_load_dwordx16 s[36:51], s[0:1], 0
    s_load_dwordx8 s[52:59], s[0:1], 64
    s_load_dwordx4 s[60:63], s[0:1], 96
    s_getpc_b64 s[72:73]
L_pc:
    s_bfe_u32 s7, s2, 0x30003
    s_mul_i32 s7, s7, ((L_codeend-L_pc)/1024)*128
    v_cmp_gt_u32 vcc, (L_codeend-L_pc)/1024, v0
    s_add_u32 s72, s72, s7
    s_addc_u32 s73, s73, 0
    v_lshlrev_b32 v6, 7, v0
    s_and_saveexec_b64 s[70:71], vcc
    s_cbranch_execz L_nocpf
    v_mov_b32 v7, s73
    v_add_co_u32 v6, vcc, s72, v6
    s_nop 1
    v_addc_co_u32_e64 v7, vcc, 0, v7, vcc
    global_load_dword v251, v[6:7], off
L_nocpf:
    s_mov_b64 exec, -1
    v_and_b32 v1, 63, v0
    v_lshrrev_b32_e64 v4, 6, v0
    v_lshlrev_b32 v3, 4, v1
    v_readfirstlane_b32 s4, v4
    v_mov_b32 v5, 0x7ff00000
    v_cmp_gt_u32 vcc, 56, v1
    s_lshl_b32 s5, s2, 2
    s_add_u32 s5, s5, s4
    v_cndmask_b32 v4, v5, v3, vcc
    s_mul_i32 s5, s5, 1792
    s_and_b32 s6, s2, 7
    s_mul_i32 s6, s6, 28
    s_lshr_b32 s7, s2, 3
    s_add_u32 s6, s6, s7
    s_min_u32 s64, s6, 223
    s_lshl_b32 s7, s64, 10
    v_lshl_add_u32 v6, v0, 2, s7
    v_mov_b32 v7, 0
    s_lshl_b32 s6, s64, 2
    v_mov_b32 v56, s6
    s_mov_b32 s14, 33554432
    s_mov_b32 s15, 0x00020000
    s_mov_b32 s10, 1835008
    s_mov_b32 s11, 0x00020000
    s_waitcnt lgkmcnt(0)
    s_mov_b64 s[8:9], s[36:37]
    buffer_load_dwordx4 v[48:51], v4, s[8:11], s5 offen
    buffer_load_dwordx4 v[52:55], v4, s[8:11], s5 offen offset:896
    s_mov_b32 s18, 1605632
    s_mov_b32 s19, 0x00020000
    s_mov_b32 s22, 1605632
    s_mov_b32 s23, 0x00020000
    s_mov_b32 s26, 1605632
    s_mov_b32 s27, 0x00020000
    s_mov_b32 s30, 1835008
    s_mov_b32 s31, 0x00020000
    v_cmp_lt_u32_e64 vcc, 5, v1
    v_mul_u32_u24 v4, 36864, v1
    s_lshr_b32 s5, s2, 3
    s_mul_i32 s6, s5, 37
    v_cndmask_b32_e64 v8, v4, v5, vcc
    s_lshr_b32 s6, s6, 8
    s_mul_i32 s7, s6, 7
    s_sub_u32 s69, s5, s7
    s_and_b32 s68, s2, 1
    s_and_b32 s7, s2, 6
    s_lshl_b32 s7, s7, 1
    s_add_u32 s66, s7, s6
    s_mul_i32 s67, s68, 7
    s_add_u32 s67, s67, s69
    s_lshl_b32 s78, s4, 13
    s_add_u32 s78, s78, 98304
    s_mul_i32 s81, s4, 14592
    global_load_dword v44, v6, s[38:39]
    global_load_dword v45, v6, s[40:41]
    global_load_dword v46, v6, s[42:43]
    global_load_dword v47, v6, s[44:45]
    global_load_dword v42, v56, s[46:47]
    global_load_dword v244, v56, s[48:49]
    s_mov_b64 s[12:13], s[62:63]
    s_mov_b64 s[16:17], s[52:53]
    s_mov_b64 s[20:21], s[54:55]
    s_mov_b64 s[24:25], s[56:57]
    s_mov_b64 s[28:29], s[58:59]
    buffer_load_dword v2, v7, s[12:15], 0 offen sc1
    s_bitcmp1_b32 s4, 0
    s_cselect_b64 s[88:89], s[54:55], s[52:53]
    s_lshr_b32 s5, s4, 1
    s_lshl1_add_u32 s7, s2, s5
    s_mul_i32 s5, s7, 896
    v_min_u32 v4, 6, v1
    v_lshl_add_u32 v248, v4, 7, s5
    s_mul_i32 s5, s2, 49
    s_mul_i32 s7, s4, 12
    s_add_u32 s5, s5, s7
    v_min_u32 v4, 12, v1
    v_add_lshl_u32 v245, v4, s5, 7
    v_cmp_gt_u32 vcc, 32, v1
    v_mul_u32_u24 v4, 37, v1
    v_lshrrev_b32 v4, 9, v4
    v_cndmask_b32 v243, v5, v3, vcc
    v_mul_u32_u24 v4, 10784, v4
    v_mul_u32_u24 v6, 272, v1
    s_lshl_b32 s5, s4, 2
    v_add3_u32 v240, v4, v6, s5
    v_add_u32 v241, s5, v240
    s_lshl_b32 s92, s4, 12
    s_add_u32 s92, s92, 77056
    v_and_b32 v4, 48, v1
    v_add3_u32 v242, v4, v3, s81
    v_and_b32 v4, 31, v1
    v_lshrrev_b32 v6, 5, v1
    v_lshl_add_u32 v6, v6, 4, s81
    v_and_b32_e64 v7, 28, v1
    v_lshl_add_u32 v7, v4, 5, v7
    v_add_u32_e64 v16, v6, v7
    v_mul_u32_u24 v7, 272, v4
    v_add_u32 v15, v6, v7
    v_subrev_u32 v7, 16, v4
    v_cmp_lt_u32 vcc, 20, v4
    s_lshl2_add_u32 s85, s2, s4
    s_lshl_b32 s85, s85, 8
    v_cndmask_b32 v4, v4, v7, vcc
    v_mul_u32_u24 v7, 272, v4
    v_add_u32_e64 v14, v6, v7
    s_add_u32 s85, s85, 524288
    v_lshlrev_b32_e64 v252, 25, v1
    s_mul_i32 s91, s2, 14336
    s_mul_i32 s5, s4, 3584
    s_add_u32 s91, s91, s5
    s_add_u32 s91, s91, 851968
    s_lshl_b32 s5, s4, 8
    s_add_u32 s5, s5, s2
    s_mul_i32 s5, s5, 4
    s_add_u32 s83, s5, 32768
    v_lshrrev_b32_e64 v4, 2, v1
    v_mul_u32_u24 v4, 3584, v4
    v_and_b32_e64 v6, 3, v1
    v_lshl_add_u32 v4, v6, 4, v4
    s_lshl_b32 s5, s67, 8
    s_lshl_b32 s6, s4, 6
    s_add_u32 s5, s5, s6
    v_add_u32 v9, s5, v4
    v_add_u32 v10, 56320, v9
    v_add_u32 v11, 112640, v9
    v_add_u32 v12, 168960, v9
    v_and_b32 v4, 32, v1
    v_lshlrev_b32 v4, 4, v4
    v_and_b32_e64 v7, 12, v1
    v_lshl_add_u32 v4, v7, 4, v4
    v_and_b32_e64 v7, 16, v1
    v_lshl_add_u32 v4, v7, 1, v4
    v_lshl_add_u32 v4, v6, 3, v4
    v_add_u32 v13, s78, v4
    s_mov_b32 s80, -12544
    s_movk_i32 s7, 128
    s_bfe_u32 s5, s2, 0x20001
    s_lshl_b32 s5, s5, 10
    s_lshr_b32 s84, s5, 2
    s_bfe_u32 s94, s2, 0x20003
    s_sub_u32 s95, s68, s94
    s_add_u32 s95, s95, 4
    s_mul_i32 s95, s95, 36864
    s_mul_i32 s94, s94, 36864
    s_add_u32 s94, s94, 32768
    s_add_u32 s5, s5, s94
    v_lshl_add_u32 v26, v0, 2, s5
    v_lshrrev_b32 v4, 2, v1
    v_add_u32_e64 v4, s6, v4
    v_mul_u32_u24 v7, 14336, v4
    v_lshrrev_b32 v4, 4, v1
    v_xor_b32 v6, v6, v4
    v_lshl_add_u32 v7, v6, 4, v7
    s_lshl_b32 s5, s64, 6
    s_add_u32 s5, s5, 851968
    v_add_u32 v27, s5, v7
    v_bfe_u32 v6, v1, 1, 2
    v_mul_u32_u24 v6, 4160, v6
    v_and_b32_e64 v7, 16, v3
    v_add3_u32 v6, v6, v7, s80
    v_lshlrev_b32 v7, 4, v0
    v_cmp_gt_u32 vcc, s7, v0
    v_mov_b32 v56, 0
    v_mov_b32 v57, 0
    v_cndmask_b32 v6, v6, v7, vcc
    v_mov_b32 v58, 0
    v_mov_b32_e64 v59, 0
    v_add_u32 v6, 75008, v6
    ds_write_b128 v6, v[56:59]
    v_lshlrev_b32_e64 v4, 3, v0
    v_sub_u32 v4, 2047, v4
    v_cvt_f32_i32_e64 v4, v4
    v_mov_b32 v60, 1028
    v_cmp_eq_u32_e64 vcc, 0, v0
    v_add_f32 v6, 0x80000000, v4
    v_add_f32_e64 v7, 0xbf800000, v4
    v_cvt_pk_bf16_f32 v6, v6, v7
    v_lshlrev_b32 v7, 16, v6
    v_cvt_u32_f32 v7, v7
    v_cndmask_b32 v7, v7, v60, vcc
    v_lshrrev_b32 v17, 5, v7
    v_add_lshl_u32 v17, v17, v7, 2
    v_and_b32 v7, 0xffff0000, v6
    v_cvt_u32_f32 v7, v7
    v_cndmask_b32 v7, v7, v60, vcc
    v_lshrrev_b32_e64 v18, 5, v7
    v_add_lshl_u32 v18, v18, v7, 2
    v_add_f32_e64 v6, 0xc0000000, v4
    v_add_f32 v7, 0xc0400000, v4
    v_cvt_pk_bf16_f32 v6, v6, v7
    v_lshlrev_b32 v7, 16, v6
    v_cvt_u32_f32 v7, v7
    v_cndmask_b32 v7, v7, v60, vcc
    v_lshrrev_b32 v19, 5, v7
    v_add_lshl_u32 v19, v19, v7, 2
    v_and_b32 v7, 0xffff0000, v6
    v_cvt_u32_f32 v7, v7
    v_cndmask_b32 v7, v7, v60, vcc
    v_lshrrev_b32_e64 v20, 5, v7
    v_add_lshl_u32 v20, v20, v7, 2
    v_add_f32_e64 v6, 0xc0800000, v4
    v_add_f32 v7, 0xc0a00000, v4
    v_cvt_pk_bf16_f32 v6, v6, v7
    v_lshlrev_b32 v7, 16, v6
    v_cvt_u32_f32 v7, v7
    v_lshrrev_b32_e64 v21, 5, v7
    v_add_lshl_u32 v21, v21, v7, 2
    v_and_b32 v7, 0xffff0000, v6
    v_cvt_u32_f32 v7, v7
    v_lshrrev_b32 v22, 5, v7
    v_add_lshl_u32 v22, v22, v7, 2
    v_add_f32 v6, 0xc0c00000, v4
    v_add_f32 v7, 0xc0e00000, v4
    v_cvt_pk_bf16_f32 v6, v6, v7
    v_lshlrev_b32 v7, 16, v6
    v_cvt_u32_f32 v7, v7
    v_lshrrev_b32_e64 v23, 5, v7
    v_add_lshl_u32 v23, v23, v7, 2
    v_and_b32 v7, 0xffff0000, v6
    v_cvt_u32_f32 v7, v7
    v_lshrrev_b32 v24, 5, v7
    v_add_lshl_u32 v24, v24, v7, 2
    v_add_f32 v6, 0xc1000000, v4
    v_cvt_pk_bf16_f32 v6, v6, v7
    v_lshlrev_b32 v7, 16, v6
    v_cvt_u32_f32 v7, v7
    v_lshrrev_b32_e64 v25, 5, v7
    v_add_lshl_u32 v25, v25, v7, 2
    v_mov_b32 v4, 255
    v_cmp_eq_u32 s[86:87], v4, v0
    v_and_b32 v4, 15, v1
    v_lshrrev_b32 v5, 4, v1
    v_lshl_add_u32 v6, v5, 3, v4
    v_sub_u32 v6, 39, v6
    v_and_b32 v7, 1, v6
    v_mul_u32_u24 v7, 4158, v7
    v_lshl_add_u32 v6, v6, 1, v7
    s_lshr_b32 s5, s4, 1
    s_andn2_b32 s3, 1, s4
    s_mul_i32 s7, s5, 8320
    s_lshl_b32 s6, s3, 8
    s_add_u32 s7, s7, s6
    s_add_u32 s7, s7, 58368
    v_add_u32_e64 v31, s7, v6
    v_add_u32 v28, 3072, v31
    v_add_u32 v29, 2048, v31
    v_add_u32 v30, 1024, v31
    v_lshlrev_b32 v6, 1, v4
    v_sub_u32 v6, v6, v5
    s_lshl4_add_u32 s6, s3, 17
    v_add_u32 v6, s6, v6
    s_mov_b32 s7, 75008
    v_bfe_u32 v7, v6, 2, 2
    v_xor_b32_e64 v7, s5, v7
    v_lshl_add_u32 v7, v6, 2, v7
    v_lshl_add_u32 v32, v7, 4, s7
    v_subrev_u32_e64 v6, 4, v6
    v_bfe_u32 v7, v6, 2, 2
    v_xor_b32_e64 v7, s5, v7
    v_lshl_add_u32 v7, v6, 2, v7
    v_lshl_add_u32 v33, v7, 4, s7
    v_subrev_u32_e64 v6, 4, v6
    v_bfe_u32 v7, v6, 2, 2
    v_xor_b32_e64 v7, s5, v7
    v_lshl_add_u32 v7, v6, 2, v7
    v_lshl_add_u32 v34, v7, 4, s7
    v_subrev_u32_e64 v6, 4, v6
    v_bfe_u32 v7, v6, 2, 2
    v_xor_b32_e64 v7, s5, v7
    v_lshl_add_u32 v7, v6, 2, v7
    v_lshl_add_u32 v35, v7, 4, s7
    s_mul_i32 s90, s4, 7168
    v_add_u32 v39, s90, v3
    v_lshlrev_b32 v38, 4, v0
    s_mul_i32 s43, s64, 4352
    s_add_u32 s43, s43, 4521984
    global_load_dword v254, v248, s[88:89]
    global_load_dword v253, v245, s[56:57]
    s_mov_b32 s80, 0x3b124925
    v_mov_b32 v4, 0x3727c5ac
    s_mov_b32 exec_hi, 0x00ffffff
    s_waitcnt vmcnt(10)
    v_lshlrev_b32 v56, 16, v48
    v_and_b32 v57, 0xffff0000, v48
    v_lshlrev_b32_e64 v58, 16, v49
    v_and_b32 v59, 0xffff0000, v49
    v_lshlrev_b32_e64 v60, 16, v50
    v_and_b32 v61, 0xffff0000, v50
    v_lshlrev_b32_e64 v62, 16, v51
    v_and_b32 v63, 0xffff0000, v51
    v_readfirstlane_b32 s70, v56
    s_waitcnt vmcnt(9)
    v_lshlrev_b32_e64 v64, 16, v52
    v_and_b32 v65, 0xffff0000, v52
    v_lshlrev_b32_e64 v66, 16, v53
    v_and_b32 v67, 0xffff0000, v53
    v_lshlrev_b32_e64 v68, 16, v54
    v_and_b32 v69, 0xffff0000, v54
    v_lshlrev_b32 v70, 16, v55
    v_and_b32 v71, 0xffff0000, v55
    v_readfirstlane_b32 s72, v64
    ds_write2_b32 v241, v48, v52 offset0:8 offset1:9
    ds_write2_b32 v241, v49, v53 offset0:24 offset1:25
    ds_write2_b32 v241, v50, v54 offset0:40 offset1:41
    ds_write2_b32 v241, v51, v55 offset0:56 offset1:57
    v_pk_add_f32 v[56:57], v[56:57], s[70:71] op_sel_hi:[1,0] neg_lo:[0,1] neg_hi:[0,1]
    v_pk_add_f32 v[58:59], v[58:59], s[70:71] op_sel_hi:[1,0] neg_lo:[0,1] neg_hi:[0,1]
    v_pk_add_f32 v[60:61], v[60:61], s[70:71] op_sel_hi:[1,0] neg_lo:[0,1] neg_hi:[0,1]
    v_pk_add_f32 v[62:63], v[62:63], s[70:71] op_sel_hi:[1,0] neg_lo:[0,1] neg_hi:[0,1]
    v_pk_add_f32 v[64:65], v[64:65], s[72:73] op_sel_hi:[1,0] neg_lo:[0,1] neg_hi:[0,1]
    v_pk_add_f32 v[66:67], v[66:67], s[72:73] op_sel_hi:[1,0] neg_lo:[0,1] neg_hi:[0,1]
    v_pk_add_f32 v[68:69], v[68:69], s[72:73] op_sel_hi:[1,0] neg_lo:[0,1] neg_hi:[0,1]
    v_pk_add_f32 v[70:71], v[70:71], s[72:73] op_sel_hi:[1,0] neg_lo:[0,1] neg_hi:[0,1]
    v_pk_add_f32 v[72:73], v[56:57], v[58:59]
    v_pk_mul_f32 v[74:75], v[56:57], v[56:57]
    v_pk_add_f32 v[72:73], v[72:73], v[60:61]
    v_pk_fma_f32 v[74:75], v[58:59], v[58:59], v[74:75]
    v_pk_fma_f32 v[74:75], v[60:61], v[60:61], v[74:75]
    v_pk_fma_f32 v[74:75], v[62:63], v[62:63], v[74:75]
    v_pk_add_f32 v[72:73], v[72:73], v[62:63]
    v_pk_add_f32 v[80:81], v[64:65], v[66:67]
    v_pk_mul_f32 v[82:83], v[64:65], v[64:65]
    v_pk_add_f32 v[80:81], v[80:81], v[68:69]
    v_pk_fma_f32 v[82:83], v[66:67], v[66:67], v[82:83]
    v_pk_fma_f32 v[82:83], v[68:69], v[68:69], v[82:83]
    v_pk_fma_f32 v[82:83], v[70:71], v[70:71], v[82:83]
    v_pk_add_f32 v[80:81], v[80:81], v[70:71]
    v_add_f32 v88, v72, v73
    v_add_f32 v90, v74, v75
    v_add_f32 v89, v80, v81
    v_add_f32 v91, v82, v83
    v_add_f32_dpp v88, v88, v88 row_shr:1 row_mask:0xf bank_mask:0xf bound_ctrl:0
    v_add_f32_dpp v90, v90, v90 row_shr:1 row_mask:0xf bank_mask:0xf bound_ctrl:0
    v_add_f32_dpp v89, v89, v89 row_shr:1 row_mask:0xf bank_mask:0xf bound_ctrl:0
    v_add_f32_dpp v91, v91, v91 row_shr:1 row_mask:0xf bank_mask:0xf bound_ctrl:0
    v_add_f32_dpp v88, v88, v88 row_shr:2 row_mask:0xf bank_mask:0xf bound_ctrl:0
    v_add_f32_dpp v90, v90, v90 row_shr:2 row_mask:0xf bank_mask:0xf bound_ctrl:0
    v_add_f32_dpp v89, v89, v89 row_shr:2 row_mask:0xf bank_mask:0xf bound_ctrl:0
    v_add_f32_dpp v91, v91, v91 row_shr:2 row_mask:0xf bank_mask:0xf bound_ctrl:0
    v_add_f32_dpp v88, v88, v88 row_shr:4 row_mask:0xf bank_mask:0xf bound_ctrl:0
    v_add_f32_dpp v90, v90, v90 row_shr:4 row_mask:0xf bank_mask:0xf bound_ctrl:0
    v_add_f32_dpp v89, v89, v89 row_shr:4 row_mask:0xf bank_mask:0xf bound_ctrl:0
    v_add_f32_dpp v91, v91, v91 row_shr:4 row_mask:0xf bank_mask:0xf bound_ctrl:0
    v_add_f32_dpp v88, v88, v88 row_shr:8 row_mask:0xf bank_mask:0xf bound_ctrl:0
    v_add_f32_dpp v90, v90, v90 row_shr:8 row_mask:0xf bank_mask:0xf bound_ctrl:0
    v_add_f32_dpp v89, v89, v89 row_shr:8 row_mask:0xf bank_mask:0xf bound_ctrl:0
    v_add_f32_dpp v91, v91, v91 row_shr:8 row_mask:0xf bank_mask:0xf bound_ctrl:0
    v_add_f32_dpp v88, v88, v88 row_bcast:15 row_mask:0xa bank_mask:0xf
    v_add_f32_dpp v90, v90, v90 row_bcast:15 row_mask:0xa bank_mask:0xf
    v_add_f32_dpp v89, v89, v89 row_bcast:15 row_mask:0xa bank_mask:0xf
    v_add_f32_dpp v91, v91, v91 row_bcast:15 row_mask:0xa bank_mask:0xf
    v_add_f32_dpp v88, v88, v88 row_bcast:31 row_mask:0xc bank_mask:0xf
    v_add_f32_dpp v90, v90, v90 row_bcast:31 row_mask:0xc bank_mask:0xf
    v_add_f32_dpp v89, v89, v89 row_bcast:31 row_mask:0xc bank_mask:0xf
    v_add_f32_dpp v91, v91, v91 row_bcast:31 row_mask:0xc bank_mask:0xf
    v_pk_mul_f32 v[88:89], v[88:89], s[80:81] op_sel_hi:[1,0]
    v_pk_fma_f32 v[90:91], v[90:91], s[80:81], v[4:5] op_sel_hi:[1,0,0]
    v_pk_fma_f32 v[90:91], v[88:89], v[88:89], v[90:91] neg_lo:[1,0,0] neg_hi:[1,0,0]
    v_max_f32 v90, v90, v4
    v_max_f32 v91, v91, v4
    v_rsq_f32 v90, v90
    v_rsq_f32 v91, v91
    s_nop 0
    v_pk_mul_f32 v[88:89], v[88:89], v[90:91] neg_lo:[1,0] neg_hi:[1,0]
    v_readlane_b32 s70, v90, 55
    v_readlane_b32 s72, v91, 55
    v_readlane_b32 s71, v88, 55
    v_readlane_b32 s73, v89, 55
    s_nop 0
    v_pk_fma_f32 v[56:57], v[56:57], s[70:71], s[70:71] op_sel:[0,0,1] op_sel_hi:[1,0,1]
    v_pk_fma_f32 v[58:59], v[58:59], s[70:71], s[70:71] op_sel:[0,0,1] op_sel_hi:[1,0,1]
    v_pk_fma_f32 v[60:61], v[60:61], s[70:71], s[70:71] op_sel:[0,0,1] op_sel_hi:[1,0,1]
    v_pk_fma_f32 v[62:63], v[62:63], s[70:71], s[70:71] op_sel:[0,0,1] op_sel_hi:[1,0,1]
    v_pk_fma_f32 v[64:65], v[64:65], s[72:73], s[72:73] op_sel:[0,0,1] op_sel_hi:[1,0,1]
    v_pk_fma_f32 v[66:67], v[66:67], s[72:73], s[72:73] op_sel:[0,0,1] op_sel_hi:[1,0,1]
    v_pk_fma_f32 v[68:69], v[68:69], s[72:73], s[72:73] op_sel:[0,0,1] op_sel_hi:[1,0,1]
    v_pk_fma_f32 v[70:71], v[70:71], s[72:73], s[72:73] op_sel:[0,0,1] op_sel_hi:[1,0,1]
    v_cvt_pk_bf16_f32 v72, v56, v64
    v_cvt_pk_bf16_f32 v73, v57, v65
    v_cvt_pk_bf16_f32 v74, v58, v66
    v_cvt_pk_bf16_f32 v75, v59, v67
    v_cvt_pk_bf16_f32 v76, v60, v68
    v_cvt_pk_bf16_f32 v77, v61, v69
    v_cvt_pk_bf16_f32 v78, v62, v70
    v_cvt_pk_bf16_f32 v79, v63, v71
    ds_write2_b32 v240, v72, v73 offset0:0 offset1:4
    ds_write2_b32 v240, v74, v75 offset0:16 offset1:20
    ds_write2_b32 v240, v76, v77 offset0:32 offset1:36
    ds_write2_b32 v240, v78, v79 offset0:48 offset1:52
    s_mov_b64 exec, -1
    v_and_b32 v4, 60, v1
    v_lshlrev_b32_e64 v4, 25, v4
    v_lshl_add_u32 v40, v1, 10, v4
    v_and_b32 v4, 62, v1
    v_lshlrev_b32 v4, 25, v4
    v_lshl_add_u32 v43, v1, 12, v4
    s_lshl1_add_u32 s5, s4, s68
    s_lshl_b32 s5, s5, 12
    s_add_u32 s84, s84, s5
    s_add_u32 s84, s84, 524288
    s_lshr_b32 s5, s66, 2
    s_bfe_u32 s94, s2, 0x20003
    s_lshl3_add_u32 s5, s5, s94
    s_lshl2_add_u32 s5, s5, s4
    s_lshl_b32 s5, s5, 8
    s_add_u32 s40, s5, 524288
    s_lshl2_add_u32 s7, s69, s4
    s_lshl2_add_u32 s3, s7, s94
    s_lshl_b32 s3, s3, 8
    s_add_u32 s41, s3, 753664
    s_mul_i32 s7, s7, 57344
    s_add_u32 s45, s7, 13811712
    s_mul_i32 s6, s4, 243712
    s_lshl_b32 s5, s66, 8
    s_add_u32 s5, s5, s6
    s_add_u32 s44, s5, 4521984
    s_lshl_b32 s5, s4, 3
    s_and_b32 s5, s5, 16
    s_and_b32 m0, s81, 0x7fffffff
    s_waitcnt lgkmcnt(0)
    s_barrier
    ds_read_b128 v[112:115], v242 offset:0
    ds_read_b128 v[116:119], v242 offset:1088
    ds_read_b128 v[120:123], v242 offset:2176
    ds_read_b128 v[124:127], v242 offset:3264
    s_mov_b64 exec, 0
    s_cmp_eq_u32 s4, 0
    s_cbranch_scc1 L_early0
    s_cmp_eq_u32 s4, 1
    s_cbranch_scc1 L_early1
    s_cmp_eq_u32 s4, 2
    s_cbranch_scc1 L_early2
    s_branch L_early3
L_early_back:
    s_mov_b64 exec, -1
    s_waitcnt lgkmcnt(0)
    buffer_store_dwordx4 v[112:115], v3, s[12:15], s91 offen offset:0 sc1
    buffer_store_dwordx4 v[116:119], v3, s[12:15], s91 offen offset:1024 sc1
    buffer_store_dwordx4 v[120:123], v3, s[12:15], s91 offen offset:2048 sc1
    buffer_store_dwordx4 v[124:127], v243, s[12:15], s91 offen offset:3072 sc1
    s_cmp_lt_u32 s2, 224
    s_cbranch_scc1 L_main
    s_waitcnt vmcnt(6)
    v_readfirstlane_b32 s32, v2
    s_mul_i32 s32, s32, 1664525
    s_add_u32 s32, s32, 1013904223
    v_mov_b32 v2, s32
    buffer_store_dword v2, v252, s[12:15], s85 offen sc1
    s_add_u32 s46, s32, 28
    s_add_u32 s47, s32, 14
    s_waitcnt vmcnt(0)
    buffer_atomic_swap v2, v8, s[12:15], s83 offen
    s_branch L_spare
L_main:
    s_waitcnt vmcnt(8)
    v_lshrrev_b32 v4, s5, v42
    v_lshlrev_b32_e64 v4, 16, v4
    v_mul_f32 v4, 0x3fb8aa3b, v4
    v_exp_f32_e64 v4, v4
    s_waitcnt vmcnt(7)
    v_readfirstlane_b32 s65, v244
    v_cvt_pk_bf16_f32 v42, v4, v4
    v_and_b32 v42, 0xffff0000, v42
    v_mul_f32 v249, 0.15915494, v42
    v_add_f32 v250, v42, v42
    v_mul_f32 v42, 0xbfb8aa3b, v42
    v_lshlrev_b32 v48, 16, v44
    v_lshlrev_b32 v49, 16, v45
    v_lshlrev_b32 v50, 16, v46
    v_lshlrev_b32 v51, 16, v47
    v_mul_f32 v48, 0x3fb8aa3b, v48
    v_exp_f32 v48, v48
    v_mul_f32 v49, v49, v249
    v_cvt_pk_bf16_f32 v48, v48, v48
    v_mul_f32_e64 v50, v50, v250
    v_and_b32 v48, 0xffff0000, v48
    v_mul_f32 v51, v51, v250
    v_mul_f32 v48, v48, v42
    v_fract_f32 v5, v49
    v_exp_f32 v4, v48
    v_cos_f32 v52, v5
    v_sin_f32 v53, v5
    v_mul_f32 v52, v52, v4
    v_mul_f32 v53, v53, v4
    v_mul_f32 v5, 0x43800000, v49
    v_mul_f32 v4, 0x43800000, v48
    v_fract_f32 v5, v5
    v_exp_f32 v4, v4
    v_cos_f32 v56, v5
    v_sin_f32 v57, v5
    v_mul_f32 v56, v56, v4
    v_mul_f32 v57, v57, v4
    s_waitcnt vmcnt(6)
    v_readfirstlane_b32 s32, v2
    s_mul_i32 s32, s32, 1664525
    s_add_u32 s32, s32, 1013904223
    v_mov_b32 v2, s32
    buffer_store_dword v2, v252, s[12:15], s85 offen sc1
    s_add_u32 s46, s32, 28
    s_add_u32 s47, s32, 14
    v_mov_b32 v192, 0x3f80
    v_cvt_pk_bf16_f32 v193, v50, -v51
    v_pk_mul_f32 v[58:59], v[52:53], v[52:53] op_sel:[0,0] op_sel_hi:[0,1]
    v_pk_fma_f32 v[58:59], v[52:53], v[52:53], v[58:59] op_sel:[1,1,0] op_sel_hi:[1,0,1] neg_lo:[1,0,0]
    v_pk_mul_f32 v[60:61], v[50:51], v[56:57] op_sel:[0,0] op_sel_hi:[0,1]
    v_pk_fma_f32 v[60:61], v[50:51], v[56:57], v[60:61] op_sel:[1,1,0] op_sel_hi:[1,0,1] neg_lo:[1,0,0]
    v_cvt_pk_bf16_f32 v194, v60, -v61
    v_pk_mul_f32 v[62:63], v[56:57], v[56:57] op_sel:[0,0] op_sel_hi:[0,1]
    v_pk_fma_f32 v[62:63], v[56:57], v[56:57], v[62:63] op_sel:[1,1,0] op_sel_hi:[1,0,1] neg_lo:[1,0,0]
L_pad0:
    s_cbranch_execz L_early_back
    v_pk_mul_f32 v[64:65], v[50:51], v[52:53] op_sel:[0,0] op_sel_hi:[0,1]
    v_pk_fma_f32 v[64:65], v[50:51], v[52:53], v[64:65] op_sel:[1,1,0] op_sel_hi:[1,0,1] neg_lo:[1,0,0]
    v_cvt_pk_bf16_f32 v195, v64, -v65
    v_pk_mul_f32 v[66:67], v[58:59], v[58:59] op_sel:[0,0] op_sel_hi:[0,1]
    v_pk_fma_f32 v[66:67], v[58:59], v[58:59], v[66:67] op_sel:[1,1,0] op_sel_hi:[1,0,1] neg_lo:[1,0,0]
    v_pk_mul_f32 v[68:69], v[50:51], v[62:63] op_sel:[0,0] op_sel_hi:[0,1]
    v_pk_fma_f32 v[68:69], v[50:51], v[62:63], v[68:69] op_sel:[1,1,0] op_sel_hi:[1,0,1] neg_lo:[1,0,0]
    v_cvt_pk_bf16_f32 v196, v68, -v69
    v_pk_mul_f32 v[70:71], v[60:61], v[62:63] op_sel:[0,0] op_sel_hi:[0,1]
    v_pk_fma_f32 v[70:71], v[60:61], v[62:63], v[70:71] op_sel:[1,1,0] op_sel_hi:[1,0,1] neg_lo:[1,0,0]
    v_cvt_pk_bf16_f32 v197, v70, -v71
    ds_write_addtid_b32 v192
    ds_write_addtid_b32 v193 offset:8704
    ds_write_addtid_b32 v194 offset:10880
    ds_write_addtid_b32 v195 offset:8976
    ds_write_addtid_b32 v196 offset:11424
    ds_write_addtid_b32 v197 offset:11696
    v_pk_mul_f32 v[72:73], v[62:63], v[62:63] op_sel:[0,0] op_sel_hi:[0,1]
    v_pk_fma_f32 v[72:73], v[62:63], v[62:63], v[72:73] op_sel:[1,1,0] op_sel_hi:[1,0,1] neg_lo:[1,0,0]
    v_pk_mul_f32 v[74:75], v[66:67], v[66:67] op_sel:[0,0] op_sel_hi:[0,1]
    v_pk_fma_f32 v[74:75], v[66:67], v[66:67], v[74:75] op_sel:[1,1,0] op_sel_hi:[1,0,1] neg_lo:[1,0,0]
    v_cvt_pk_bf16_f32 v198, v74, v75
    v_pk_mul_f32 v[76:77], v[50:51], v[58:59] op_sel:[0,0] op_sel_hi:[0,1]
    v_pk_fma_f32 v[76:77], v[50:51], v[58:59], v[76:77] op_sel:[1,1,0] op_sel_hi:[1,0,1] neg_lo:[1,0,0]
    v_cvt_pk_bf16_f32 v199, v76, -v77
    v_pk_mul_f32 v[54:55], v[74:75], v[74:75] op_sel:[0,0] op_sel_hi:[0,1]
    v_pk_fma_f32 v[54:55], v[74:75], v[74:75], v[54:55] op_sel:[1,1,0] op_sel_hi:[1,0,1] neg_lo:[1,0,0]
    v_cvt_pk_bf16_f32 v200, v54, v55
    v_pk_mul_f32 v[78:79], v[64:65], v[58:59] op_sel:[0,0] op_sel_hi:[0,1]
    v_pk_fma_f32 v[78:79], v[64:65], v[58:59], v[78:79] op_sel:[1,1,0] op_sel_hi:[1,0,1] neg_lo:[1,0,0]
    v_cvt_pk_bf16_f32 v201, v78, -v79
    v_pk_mul_f32 v[80:81], v[54:55], v[54:55] op_sel:[0,0] op_sel_hi:[0,1]
    v_pk_fma_f32 v[80:81], v[54:55], v[54:55], v[80:81] op_sel:[1,1,0] op_sel_hi:[1,0,1] neg_lo:[1,0,0]
    v_cvt_pk_bf16_f32 v202, v80, v81
    v_pk_mul_f32 v[82:83], v[60:61], v[58:59] op_sel:[0,0] op_sel_hi:[0,1]
    v_pk_fma_f32 v[82:83], v[60:61], v[58:59], v[82:83] op_sel:[1,1,0] op_sel_hi:[1,0,1] neg_lo:[1,0,0]
    v_cvt_pk_bf16_f32 v203, v82, -v83
    ds_write_addtid_b32 v198 offset:272
    ds_write_addtid_b32 v199 offset:9248
    ds_write_addtid_b32 v200 offset:544
    ds_write_addtid_b32 v201 offset:9520
    ds_write_addtid_b32 v202 offset:1088
    ds_write_addtid_b32 v203 offset:11152
    s_add_u32 m0, s78, 0
    s_mov_b32 s79, 0
    buffer_load_dwordx4 v9, s[16:19], s79 offen lds
    s_and_b32 m0, s81, 0x7fffffff
    v_pk_mul_f32 v[84:85], v[80:81], v[80:81] op_sel:[0,0] op_sel_hi:[0,1]
    v_pk_fma_f32 v[84:85], v[80:81], v[80:81], v[84:85] op_sel:[1,1,0] op_sel_hi:[1,0,1] neg_lo:[1,0,0]
    v_cvt_pk_bf16_f32 v204, v84, v85
    v_pk_mul_f32 v[86:87], v[80:81], v[54:55] op_sel:[0,0] op_sel_hi:[0,1]
    v_pk_fma_f32 v[86:87], v[80:81], v[54:55], v[86:87] op_sel:[1,1,0] op_sel_hi:[1,0,1] neg_lo:[1,0,0]
    v_cvt_pk_bf16_f32 v205, v86, v87
    v_pk_mul_f32 v[88:89], v[50:51], v[72:73] op_sel:[0,0] op_sel_hi:[0,1]
    v_pk_fma_f32 v[88:89], v[50:51], v[72:73], v[88:89] op_sel:[1,1,0] op_sel_hi:[1,0,1] neg_lo:[1,0,0]
    v_cvt_pk_bf16_f32 v206, v88, -v89
    v_pk_mul_f32 v[90:91], v[84:85], v[84:85] op_sel:[0,0] op_sel_hi:[0,1]
    v_pk_fma_f32 v[90:91], v[84:85], v[84:85], v[90:91] op_sel:[1,1,0] op_sel_hi:[1,0,1] neg_lo:[1,0,0]
    v_cvt_pk_bf16_f32 v207, v90, v91
    v_pk_mul_f32 v[92:93], v[54:55], v[74:75] op_sel:[0,0] op_sel_hi:[0,1]
    v_pk_fma_f32 v[92:93], v[54:55], v[74:75], v[92:93] op_sel:[1,1,0] op_sel_hi:[1,0,1] neg_lo:[1,0,0]
    v_cvt_pk_bf16_f32 v192, v92, v93
    v_pk_mul_f32 v[94:95], v[80:81], v[74:75] op_sel:[0,0] op_sel_hi:[0,1]
    v_pk_fma_f32 v[94:95], v[80:81], v[74:75], v[94:95] op_sel:[1,1,0] op_sel_hi:[1,0,1] neg_lo:[1,0,0]
    v_cvt_pk_bf16_f32 v193, v94, v95
    ds_write_addtid_b32 v204 offset:2176
    ds_write_addtid_b32 v205 offset:1632
    ds_write_addtid_b32 v206 offset:13056
    ds_write_addtid_b32 v207 offset:4352
    ds_write_addtid_b32 v192 offset:816
    ds_write_addtid_b32 v193 offset:1360
    s_add_u32 m0, s78, 0
    s_nop 0
    buffer_load_dwordx4 v10, s[16:19], s79 offen offset:1024 lds
    s_and_b32 m0, s81, 0x7fffffff
    v_pk_mul_f32 v[96:97], v[86:87], v[74:75] op_sel:[0,0] op_sel_hi:[0,1]
    v_pk_fma_f32 v[96:97], v[86:87], v[74:75], v[96:97] op_sel:[1,1,0] op_sel_hi:[1,0,1] neg_lo:[1,0,0]
    v_cvt_pk_bf16_f32 v194, v96, v97
    v_pk_mul_f32 v[98:99], v[90:91], v[84:85] op_sel:[0,0] op_sel_hi:[0,1]
    v_pk_fma_f32 v[98:99], v[90:91], v[84:85], v[98:99] op_sel:[1,1,0] op_sel_hi:[1,0,1] neg_lo:[1,0,0]
    v_cvt_pk_bf16_f32 v195, v98, v99
    v_pk_mul_f32 v[104:105], v[50:51], v[66:67] op_sel:[0,0] op_sel_hi:[0,1]
    v_pk_fma_f32 v[104:105], v[50:51], v[66:67], v[104:105] op_sel:[1,1,0] op_sel_hi:[1,0,1] neg_lo:[1,0,0]
    v_cvt_pk_bf16_f32 v196, v104, -v105
    v_pk_mul_f32 v[106:107], v[64:65], v[66:67] op_sel:[0,0] op_sel_hi:[0,1]
    v_pk_fma_f32 v[106:107], v[64:65], v[66:67], v[106:107] op_sel:[1,1,0] op_sel_hi:[1,0,1] neg_lo:[1,0,0]
    v_cvt_pk_bf16_f32 v197, v106, -v107
    v_pk_mul_f32 v[108:109], v[76:77], v[66:67] op_sel:[0,0] op_sel_hi:[0,1]
    v_pk_fma_f32 v[108:109], v[76:77], v[66:67], v[108:109] op_sel:[1,1,0] op_sel_hi:[1,0,1] neg_lo:[1,0,0]
    v_cvt_pk_bf16_f32 v198, v108, -v109
    v_pk_mul_f32 v[110:111], v[78:79], v[66:67] op_sel:[0,0] op_sel_hi:[0,1]
    v_pk_fma_f32 v[110:111], v[78:79], v[66:67], v[110:111] op_sel:[1,1,0] op_sel_hi:[1,0,1] neg_lo:[1,0,0]
    v_cvt_pk_bf16_f32 v199, v110, -v111
    ds_write_addtid_b32 v194 offset:1904
    ds_write_addtid_b32 v195 offset:6528
    ds_write_addtid_b32 v196 offset:9792
    ds_write_addtid_b32 v197 offset:10064
    ds_write_addtid_b32 v198 offset:10336
    ds_write_addtid_b32 v199 offset:10608
    s_add_u32 m0, s78, 0
    s_nop 0
    buffer_load_dwordx4 v11, s[16:19], s79 offen offset:2048 lds
    s_and_b32 m0, s81, 0x7fffffff
    v_pk_mul_f32 v[104:105], v[60:61], v[66:67] op_sel:[0,0] op_sel_hi:[0,1]
    v_pk_fma_f32 v[104:105], v[60:61], v[66:67], v[104:105] op_sel:[1,1,0] op_sel_hi:[1,0,1] neg_lo:[1,0,0]
    v_cvt_pk_bf16_f32 v200, v104, -v105
    v_pk_mul_f32 v[106:107], v[82:83], v[66:67] op_sel:[0,0] op_sel_hi:[0,1]
    v_pk_fma_f32 v[106:107], v[82:83], v[66:67], v[106:107] op_sel:[1,1,0] op_sel_hi:[1,0,1] neg_lo:[1,0,0]
    v_cvt_pk_bf16_f32 v201, v106, -v107
    v_pk_mul_f32 v[108:109], v[68:69], v[66:67] op_sel:[0,0] op_sel_hi:[0,1]
    v_pk_fma_f32 v[108:109], v[68:69], v[66:67], v[108:109] op_sel:[1,1,0] op_sel_hi:[1,0,1] neg_lo:[1,0,0]
    v_cvt_pk_bf16_f32 v202, v108, -v109
    v_pk_mul_f32 v[110:111], v[70:71], v[66:67] op_sel:[0,0] op_sel_hi:[0,1]
    v_pk_fma_f32 v[110:111], v[70:71], v[66:67], v[110:111] op_sel:[1,1,0] op_sel_hi:[1,0,1] neg_lo:[1,0,0]
    v_cvt_pk_bf16_f32 v203, v110, -v111
    v_pk_mul_f32 v[104:105], v[60:61], v[72:73] op_sel:[0,0] op_sel_hi:[0,1]
    v_pk_fma_f32 v[104:105], v[60:61], v[72:73], v[104:105] op_sel:[1,1,0] op_sel_hi:[1,0,1] neg_lo:[1,0,0]
    v_cvt_pk_bf16_f32 v204, v104, -v105
    v_pk_mul_f32 v[106:107], v[68:69], v[72:73] op_sel:[0,0] op_sel_hi:[0,1]
    v_pk_fma_f32 v[106:107], v[68:69], v[72:73], v[106:107] op_sel:[1,1,0] op_sel_hi:[1,0,1] neg_lo:[1,0,0]
    v_cvt_pk_bf16_f32 v205, v106, -v107
    ds_write_addtid_b32 v200 offset:11968
    ds_write_addtid_b32 v201 offset:12240
    ds_write_addtid_b32 v202 offset:12512
    ds_write_addtid_b32 v203 offset:12784
    ds_write_addtid_b32 v204 offset:13328
    ds_write_addtid_b32 v205 offset:13600
    s_add_u32 m0, s78, 0
    s_nop 0
    buffer_load_dwordx4 v12, s[16:19], s79 offen offset:3072 lds
    s_and_b32 m0, s81, 0x7fffffff
    v_pk_mul_f32 v[108:109], v[70:71], v[72:73] op_sel:[0,0] op_sel_hi:[0,1]
    v_pk_fma_f32 v[108:109], v[70:71], v[72:73], v[108:109] op_sel:[1,1,0] op_sel_hi:[1,0,1] neg_lo:[1,0,0]
    v_cvt_pk_bf16_f32 v206, v108, -v109
    v_pk_mul_f32 v[110:111], v[88:89], v[72:73] op_sel:[0,0] op_sel_hi:[0,1]
    v_pk_fma_f32 v[110:111], v[88:89], v[72:73], v[110:111] op_sel:[1,1,0] op_sel_hi:[1,0,1] neg_lo:[1,0,0]
    v_cvt_pk_bf16_f32 v207, v110, -v111
    v_pk_mul_f32 v[104:105], v[74:75], v[84:85] op_sel:[0,0] op_sel_hi:[0,1]
    v_pk_fma_f32 v[104:105], v[74:75], v[84:85], v[104:105] op_sel:[1,1,0] op_sel_hi:[1,0,1] neg_lo:[1,0,0]
    v_cvt_pk_bf16_f32 v192, v104, v105
    v_pk_mul_f32 v[106:107], v[54:55], v[84:85] op_sel:[0,0] op_sel_hi:[0,1]
    v_pk_fma_f32 v[106:107], v[54:55], v[84:85], v[106:107] op_sel:[1,1,0] op_sel_hi:[1,0,1] neg_lo:[1,0,0]
    v_cvt_pk_bf16_f32 v193, v106, v107
    v_pk_mul_f32 v[108:109], v[92:93], v[84:85] op_sel:[0,0] op_sel_hi:[0,1]
    v_pk_fma_f32 v[108:109], v[92:93], v[84:85], v[108:109] op_sel:[1,1,0] op_sel_hi:[1,0,1] neg_lo:[1,0,0]
    v_cvt_pk_bf16_f32 v194, v108, v109
    v_pk_mul_f32 v[110:111], v[80:81], v[84:85] op_sel:[0,0] op_sel_hi:[0,1]
    v_pk_fma_f32 v[110:111], v[80:81], v[84:85], v[110:111] op_sel:[1,1,0] op_sel_hi:[1,0,1] neg_lo:[1,0,0]
    v_cvt_pk_bf16_f32 v195, v110, v111
    ds_write_addtid_b32 v206 offset:13872
    ds_write_addtid_b32 v207 offset:14144
    ds_write_addtid_b32 v192 offset:2448
    ds_write_addtid_b32 v193 offset:2720
    ds_write_addtid_b32 v194 offset:2992
    ds_write_addtid_b32 v195 offset:3264
    s_add_u32 m0, s78, 4096
    s_nop 0
    buffer_load_dwordx4 v9, s[20:23], s79 offen lds
    s_and_b32 m0, s81, 0x7fffffff
    s_waitcnt vmcnt(5)
    buffer_atomic_swap v2, v8, s[12:15], s83 offen
    v_pk_mul_f32 v[104:105], v[94:95], v[84:85] op_sel:[0,0] op_sel_hi:[0,1]
    v_pk_fma_f32 v[104:105], v[94:95], v[84:85], v[104:105] op_sel:[1,1,0] op_sel_hi:[1,0,1] neg_lo:[1,0,0]
    v_cvt_pk_bf16_f32 v196, v104, v105
    v_pk_mul_f32 v[106:107], v[86:87], v[84:85] op_sel:[0,0] op_sel_hi:[0,1]
    v_pk_fma_f32 v[106:107], v[86:87], v[84:85], v[106:107] op_sel:[1,1,0] op_sel_hi:[1,0,1] neg_lo:[1,0,0]
    v_cvt_pk_bf16_f32 v197, v106, v107
    v_pk_mul_f32 v[108:109], v[96:97], v[84:85] op_sel:[0,0] op_sel_hi:[0,1]
    v_pk_fma_f32 v[108:109], v[96:97], v[84:85], v[108:109] op_sel:[1,1,0] op_sel_hi:[1,0,1] neg_lo:[1,0,0]
    v_cvt_pk_bf16_f32 v198, v108, v109
    v_pk_mul_f32 v[110:111], v[74:75], v[90:91] op_sel:[0,0] op_sel_hi:[0,1]
    v_pk_fma_f32 v[110:111], v[74:75], v[90:91], v[110:111] op_sel:[1,1,0] op_sel_hi:[1,0,1] neg_lo:[1,0,0]
    v_cvt_pk_bf16_f32 v199, v110, v111
    v_pk_mul_f32 v[104:105], v[54:55], v[90:91] op_sel:[0,0] op_sel_hi:[0,1]
    v_pk_fma_f32 v[104:105], v[54:55], v[90:91], v[104:105] op_sel:[1,1,0] op_sel_hi:[1,0,1] neg_lo:[1,0,0]
    v_cvt_pk_bf16_f32 v200, v104, v105
    v_pk_mul_f32 v[106:107], v[92:93], v[90:91] op_sel:[0,0] op_sel_hi:[0,1]
    v_pk_fma_f32 v[106:107], v[92:93], v[90:91], v[106:107] op_sel:[1,1,0] op_sel_hi:[1,0,1] neg_lo:[1,0,0]
    v_cvt_pk_bf16_f32 v201, v106, v107
    ds_write_addtid_b32 v196 offset:3536
    ds_write_addtid_b32 v197 offset:3808
    ds_write_addtid_b32 v198 offset:4080
    ds_write_addtid_b32 v199 offset:4624
    ds_write_addtid_b32 v200 offset:4896
    ds_write_addtid_b32 v201 offset:5168
    v_pk_mul_f32 v[108:109], v[80:81], v[90:91] op_sel:[0,0] op_sel_hi:[0,1]
    v_pk_fma_f32 v[108:109], v[80:81], v[90:91], v[108:109] op_sel:[1,1,0] op_sel_hi:[1,0,1] neg_lo:[1,0,0]
    v_cvt_pk_bf16_f32 v202, v108, v109
    v_pk_mul_f32 v[110:111], v[94:95], v[90:91] op_sel:[0,0] op_sel_hi:[0,1]
    v_pk_fma_f32 v[110:111], v[94:95], v[90:91], v[110:111] op_sel:[1,1,0] op_sel_hi:[1,0,1] neg_lo:[1,0,0]
    v_cvt_pk_bf16_f32 v203, v110, v111
    v_pk_mul_f32 v[104:105], v[86:87], v[90:91] op_sel:[0,0] op_sel_hi:[0,1]
    v_pk_fma_f32 v[104:105], v[86:87], v[90:91], v[104:105] op_sel:[1,1,0] op_sel_hi:[1,0,1] neg_lo:[1,0,0]
    v_cvt_pk_bf16_f32 v204, v104, v105
    v_pk_mul_f32 v[106:107], v[96:97], v[90:91] op_sel:[0,0] op_sel_hi:[0,1]
    v_pk_fma_f32 v[106:107], v[96:97], v[90:91], v[106:107] op_sel:[1,1,0] op_sel_hi:[1,0,1] neg_lo:[1,0,0]
    v_cvt_pk_bf16_f32 v205, v106, v107
    v_pk_mul_f32 v[108:109], v[74:75], v[98:99] op_sel:[0,0] op_sel_hi:[0,1]
    v_pk_fma_f32 v[108:109], v[74:75], v[98:99], v[108:109] op_sel:[1,1,0] op_sel_hi:[1,0,1] neg_lo:[1,0,0]
    v_cvt_pk_bf16_f32 v206, v108, v109
    v_pk_mul_f32 v[110:111], v[54:55], v[98:99] op_sel:[0,0] op_sel_hi:[0,1]
    v_pk_fma_f32 v[110:111], v[54:55], v[98:99], v[110:111] op_sel:[1,1,0] op_sel_hi:[1,0,1] neg_lo:[1,0,0]
    v_cvt_pk_bf16_f32 v207, v110, v111
    ds_write_addtid_b32 v202 offset:5440
    ds_write_addtid_b32 v203 offset:5712
    ds_write_addtid_b32 v204 offset:5984
    ds_write_addtid_b32 v205 offset:6256
    ds_write_addtid_b32 v206 offset:6800
    ds_write_addtid_b32 v207 offset:7072
    v_pk_mul_f32 v[104:105], v[92:93], v[98:99] op_sel:[0,0] op_sel_hi:[0,1]
    v_pk_fma_f32 v[104:105], v[92:93], v[98:99], v[104:105] op_sel:[1,1,0] op_sel_hi:[1,0,1] neg_lo:[1,0,0]
    v_cvt_pk_bf16_f32 v192, v104, v105
    v_pk_mul_f32 v[106:107], v[80:81], v[98:99] op_sel:[0,0] op_sel_hi:[0,1]
    v_pk_fma_f32 v[106:107], v[80:81], v[98:99], v[106:107] op_sel:[1,1,0] op_sel_hi:[1,0,1] neg_lo:[1,0,0]
    v_cvt_pk_bf16_f32 v193, v106, v107
    v_pk_mul_f32 v[108:109], v[94:95], v[98:99] op_sel:[0,0] op_sel_hi:[0,1]
    v_pk_fma_f32 v[108:109], v[94:95], v[98:99], v[108:109] op_sel:[1,1,0] op_sel_hi:[1,0,1] neg_lo:[1,0,0]
    v_cvt_pk_bf16_f32 v194, v108, v109
    v_pk_mul_f32 v[110:111], v[86:87], v[98:99] op_sel:[0,0] op_sel_hi:[0,1]
    v_pk_fma_f32 v[110:111], v[86:87], v[98:99], v[110:111] op_sel:[1,1,0] op_sel_hi:[1,0,1] neg_lo:[1,0,0]
    v_cvt_pk_bf16_f32 v195, v110, v111
    v_pk_mul_f32 v[104:105], v[96:97], v[98:99] op_sel:[0,0] op_sel_hi:[0,1]
    v_pk_fma_f32 v[104:105], v[96:97], v[98:99], v[104:105] op_sel:[1,1,0] op_sel_hi:[1,0,1] neg_lo:[1,0,0]
    v_cvt_pk_bf16_f32 v196, v104, v105
    ds_write_addtid_b32 v192 offset:7344
    ds_write_addtid_b32 v193 offset:7616
    ds_write_addtid_b32 v194 offset:7888
    ds_write_addtid_b32 v195 offset:8160
    ds_write_addtid_b32 v196 offset:8432
    ds_read_b128 v[112:115], v14 offset:8704
    ds_read_b128 v[116:119], v15 offset:0
    ds_read_b128 v[120:123], v14 offset:8736
    ds_read_b128 v[124:127], v15 offset:32
    ds_read_b128 v[128:131], v14 offset:8768
    ds_read_b128 v[132:135], v15 offset:64
    ds_read_b128 v[136:139], v14 offset:8800
    ds_read_b128 v[140:143], v15 offset:96
    ds_read_b128 v[144:147], v14 offset:8832
    ds_read_b128 v[148:151], v15 offset:128
    ds_read_b128 v[152:155], v14 offset:8864
    ds_read_b128 v[156:159], v15 offset:160
    ds_read_b128 v[160:163], v14 offset:8896
    ds_read_b128 v[164:167], v15 offset:192
    ds_read_b128 v[168:171], v14 offset:8928
    ds_read_b128 v[172:175], v15 offset:224
    v_and_b32 v48, 0xffff0000, v44
    v_and_b32 v49, 0xffff0000, v45
    v_and_b32 v50, 0xffff0000, v46
    v_and_b32 v51, 0xffff0000, v47
    v_mul_f32 v48, 0x3fb8aa3b, v48
    v_exp_f32 v48, v48
    v_mul_f32 v49, v49, v249
    v_cvt_pk_bf16_f32 v48, v48, v48
    v_mul_f32_e64 v50, v50, v250
    v_and_b32 v48, 0xffff0000, v48
    v_mul_f32 v51, v51, v250
    v_mul_f32 v48, v48, v42
    s_waitcnt lgkmcnt(14)
    v_mfma_f32_32x32x16_bf16 v[176:191], v[112:115], v[116:119], 0
    s_add_u32 m0, s78, 4096
    s_nop 0
    buffer_load_dwordx4 v10, s[20:23], s79 offen offset:1024 lds
    s_mov_b32 m0, s81
    s_waitcnt lgkmcnt(12)
    v_mfma_f32_32x32x16_bf16 v[176:191], v[120:123], v[124:127], v[176:191]
    v_fract_f32 v5, v49
    v_exp_f32 v4, v48
    v_cos_f32 v52, v5
    s_waitcnt lgkmcnt(10)
    v_mfma_f32_32x32x16_bf16 v[176:191], v[128:131], v[132:135], v[176:191]
    s_add_u32 m0, s78, 4096
    s_nop 0
    buffer_load_dwordx4 v11, s[20:23], s79 offen offset:2048 lds
    s_mov_b32 m0, s81
    s_waitcnt lgkmcnt(8)
    v_mfma_f32_32x32x16_bf16 v[176:191], v[136:139], v[140:143], v[176:191]
    v_sin_f32 v53, v5
    v_mul_f32_e64 v52, v52, v4
    v_mul_f32 v53, v53, v4
    v_mul_f32 v5, 0x43800000, v49
    s_waitcnt lgkmcnt(6)
    v_mfma_f32_32x32x16_bf16 v[176:191], v[144:147], v[148:151], v[176:191]
    v_mul_f32 v4, 0x43800000, v48
    v_fract_f32_e64 v5, v5
    v_exp_f32 v4, v4
    s_waitcnt lgkmcnt(4)
    v_mfma_f32_32x32x16_bf16 v[176:191], v[152:155], v[156:159], v[176:191]
    v_cos_f32 v56, v5
    v_sin_f32 v57, v5
    v_mul_f32 v56, v56, v4
    s_waitcnt lgkmcnt(2)
    v_mfma_f32_32x32x16_bf16 v[176:191], v[160:163], v[164:167], v[176:191]
    v_mul_f32 v57, v57, v4
    s_waitcnt lgkmcnt(0)
    v_mfma_f32_32x32x16_bf16 v[176:191], v[168:171], v[172:175], v[176:191]
    v_cvt_pk_bf16_f32 v192, v50, -v51
    v_pk_mul_f32 v[58:59], v[52:53], v[52:53] op_sel:[0,0] op_sel_hi:[0,1]
    v_pk_fma_f32 v[58:59], v[52:53], v[52:53], v[58:59] op_sel:[1,1,0] op_sel_hi:[1,0,1] neg_lo:[1,0,0]
    v_pk_mul_f32 v[60:61], v[50:51], v[56:57] op_sel:[0,0] op_sel_hi:[0,1]
    v_pk_fma_f32 v[60:61], v[50:51], v[56:57], v[60:61] op_sel:[1,1,0] op_sel_hi:[1,0,1] neg_lo:[1,0,0]
    v_cvt_pk_bf16_f32 v193, v60, -v61
    v_pk_mul_f32 v[62:63], v[56:57], v[56:57] op_sel:[0,0] op_sel_hi:[0,1]
    v_pk_fma_f32 v[62:63], v[56:57], v[56:57], v[62:63] op_sel:[1,1,0] op_sel_hi:[1,0,1] neg_lo:[1,0,0]
    v_pk_mul_f32 v[64:65], v[50:51], v[52:53] op_sel:[0,0] op_sel_hi:[0,1]
    v_pk_fma_f32 v[64:65], v[50:51], v[52:53], v[64:65] op_sel:[1,1,0] op_sel_hi:[1,0,1] neg_lo:[1,0,0]
    v_cvt_pk_bf16_f32 v194, v64, -v65
    v_pk_mul_f32 v[66:67], v[58:59], v[58:59] op_sel:[0,0] op_sel_hi:[0,1]
    v_pk_fma_f32 v[66:67], v[58:59], v[58:59], v[66:67] op_sel:[1,1,0] op_sel_hi:[1,0,1] neg_lo:[1,0,0]
    v_pk_mul_f32 v[68:69], v[50:51], v[62:63] op_sel:[0,0] op_sel_hi:[0,1]
    v_pk_fma_f32 v[68:69], v[50:51], v[62:63], v[68:69] op_sel:[1,1,0] op_sel_hi:[1,0,1] neg_lo:[1,0,0]
    v_cvt_pk_bf16_f32 v195, v68, -v69
    v_pk_mul_f32 v[70:71], v[60:61], v[62:63] op_sel:[0,0] op_sel_hi:[0,1]
    v_pk_fma_f32 v[70:71], v[60:61], v[62:63], v[70:71] op_sel:[1,1,0] op_sel_hi:[1,0,1] neg_lo:[1,0,0]
    v_cvt_pk_bf16_f32 v196, v70, -v71
    v_pk_mul_f32 v[72:73], v[62:63], v[62:63] op_sel:[0,0] op_sel_hi:[0,1]
    v_pk_fma_f32 v[72:73], v[62:63], v[62:63], v[72:73] op_sel:[1,1,0] op_sel_hi:[1,0,1] neg_lo:[1,0,0]
    v_pk_mul_f32 v[74:75], v[66:67], v[66:67] op_sel:[0,0] op_sel_hi:[0,1]
    v_pk_fma_f32 v[74:75], v[66:67], v[66:67], v[74:75] op_sel:[1,1,0] op_sel_hi:[1,0,1] neg_lo:[1,0,0]
    v_cvt_pk_bf16_f32 v197, v74, v75
    ds_write_addtid_b32 v192 offset:8704
    ds_write_addtid_b32 v193 offset:10880
    ds_write_addtid_b32 v194 offset:8976
    ds_write_addtid_b32 v195 offset:11424
    ds_write_addtid_b32 v196 offset:11696
    ds_write_addtid_b32 v197 offset:272
    s_add_u32 m0, s78, 4096
    s_nop 0
    buffer_load_dwordx4 v12, s[20:23], s79 offen offset:3072 lds
    s_mov_b32 m0, s81
    v_pk_mul_f32 v[76:77], v[50:51], v[58:59] op_sel:[0,0] op_sel_hi:[0,1]
    v_pk_fma_f32 v[76:77], v[50:51], v[58:59], v[76:77] op_sel:[1,1,0] op_sel_hi:[1,0,1] neg_lo:[1,0,0]
    v_cvt_pk_bf16_f32 v198, v76, -v77
    v_pk_mul_f32 v[54:55], v[74:75], v[74:75] op_sel:[0,0] op_sel_hi:[0,1]
    v_pk_fma_f32 v[54:55], v[74:75], v[74:75], v[54:55] op_sel:[1,1,0] op_sel_hi:[1,0,1] neg_lo:[1,0,0]
    v_cvt_pk_bf16_f32 v199, v54, v55
    v_pk_mul_f32 v[78:79], v[64:65], v[58:59] op_sel:[0,0] op_sel_hi:[0,1]
    v_pk_fma_f32 v[78:79], v[64:65], v[58:59], v[78:79] op_sel:[1,1,0] op_sel_hi:[1,0,1] neg_lo:[1,0,0]
    v_cvt_pk_bf16_f32 v200, v78, -v79
    v_pk_mul_f32 v[80:81], v[54:55], v[54:55] op_sel:[0,0] op_sel_hi:[0,1]
    v_pk_fma_f32 v[80:81], v[54:55], v[54:55], v[80:81] op_sel:[1,1,0] op_sel_hi:[1,0,1] neg_lo:[1,0,0]
    v_cvt_pk_bf16_f32 v201, v80, v81
    v_pk_mul_f32 v[82:83], v[60:61], v[58:59] op_sel:[0,0] op_sel_hi:[0,1]
    v_pk_fma_f32 v[82:83], v[60:61], v[58:59], v[82:83] op_sel:[1,1,0] op_sel_hi:[1,0,1] neg_lo:[1,0,0]
    v_cvt_pk_bf16_f32 v202, v82, -v83
    v_pk_mul_f32 v[84:85], v[80:81], v[80:81] op_sel:[0,0] op_sel_hi:[0,1]
    v_pk_fma_f32 v[84:85], v[80:81], v[80:81], v[84:85] op_sel:[1,1,0] op_sel_hi:[1,0,1] neg_lo:[1,0,0]
    v_cvt_pk_bf16_f32 v203, v84, v85
    ds_write_addtid_b32 v198 offset:9248
    ds_write_addtid_b32 v199 offset:544
    ds_write_addtid_b32 v200 offset:9520
    ds_write_addtid_b32 v201 offset:1088
    ds_write_addtid_b32 v202 offset:11152
    ds_write_addtid_b32 v203 offset:2176
    s_add_u32 m0, s78, 32768
    s_mov_b32 s79, 229376
    buffer_load_dwordx4 v9, s[16:19], s79 offen lds
    s_and_b32 m0, s81, 0x7fffffff
    v_pk_mul_f32 v[86:87], v[80:81], v[54:55] op_sel:[0,0] op_sel_hi:[0,1]
    v_pk_fma_f32 v[86:87], v[80:81], v[54:55], v[86:87] op_sel:[1,1,0] op_sel_hi:[1,0,1] neg_lo:[1,0,0]
    v_cvt_pk_bf16_f32 v204, v86, v87
    v_pk_mul_f32 v[88:89], v[50:51], v[72:73] op_sel:[0,0] op_sel_hi:[0,1]
    v_pk_fma_f32 v[88:89], v[50:51], v[72:73], v[88:89] op_sel:[1,1,0] op_sel_hi:[1,0,1] neg_lo:[1,0,0]
    v_cvt_pk_bf16_f32 v205, v88, -v89
    v_pk_mul_f32 v[90:91], v[84:85], v[84:85] op_sel:[0,0] op_sel_hi:[0,1]
    v_pk_fma_f32 v[90:91], v[84:85], v[84:85], v[90:91] op_sel:[1,1,0] op_sel_hi:[1,0,1] neg_lo:[1,0,0]
    v_cvt_pk_bf16_f32 v206, v90, v91
    v_pk_mul_f32 v[92:93], v[54:55], v[74:75] op_sel:[0,0] op_sel_hi:[0,1]
    v_pk_fma_f32 v[92:93], v[54:55], v[74:75], v[92:93] op_sel:[1,1,0] op_sel_hi:[1,0,1] neg_lo:[1,0,0]
    v_cvt_pk_bf16_f32 v207, v92, v93
    v_pk_mul_f32 v[94:95], v[80:81], v[74:75] op_sel:[0,0] op_sel_hi:[0,1]
    v_pk_fma_f32 v[94:95], v[80:81], v[74:75], v[94:95] op_sel:[1,1,0] op_sel_hi:[1,0,1] neg_lo:[1,0,0]
    v_cvt_pk_bf16_f32 v192, v94, v95
    v_pk_mul_f32 v[96:97], v[86:87], v[74:75] op_sel:[0,0] op_sel_hi:[0,1]
    v_pk_fma_f32 v[96:97], v[86:87], v[74:75], v[96:97] op_sel:[1,1,0] op_sel_hi:[1,0,1] neg_lo:[1,0,0]
    v_cvt_pk_bf16_f32 v193, v96, v97
    ds_write_addtid_b32 v204 offset:1632
    ds_write_addtid_b32 v205 offset:13056
    ds_write_addtid_b32 v206 offset:4352
    ds_write_addtid_b32 v207 offset:816
    ds_write_addtid_b32 v192 offset:1360
    ds_write_addtid_b32 v193 offset:1904
    s_add_u32 m0, s78, 32768
    s_nop 0
    buffer_load_dwordx4 v10, s[16:19], s79 offen offset:1024 lds
    s_mov_b32 m0, s81
    v_pk_mul_f32 v[98:99], v[90:91], v[84:85] op_sel:[0,0] op_sel_hi:[0,1]
    v_pk_fma_f32 v[98:99], v[90:91], v[84:85], v[98:99] op_sel:[1,1,0] op_sel_hi:[1,0,1] neg_lo:[1,0,0]
    v_cvt_pk_bf16_f32 v194, v98, v99
    v_pk_mul_f32 v[104:105], v[50:51], v[66:67] op_sel:[0,0] op_sel_hi:[0,1]
    v_pk_fma_f32 v[104:105], v[50:51], v[66:67], v[104:105] op_sel:[1,1,0] op_sel_hi:[1,0,1] neg_lo:[1,0,0]
    v_cvt_pk_bf16_f32 v195, v104, -v105
    v_pk_mul_f32 v[106:107], v[64:65], v[66:67] op_sel:[0,0] op_sel_hi:[0,1]
    v_pk_fma_f32 v[106:107], v[64:65], v[66:67], v[106:107] op_sel:[1,1,0] op_sel_hi:[1,0,1] neg_lo:[1,0,0]
    v_cvt_pk_bf16_f32 v196, v106, -v107
    v_pk_mul_f32 v[108:109], v[76:77], v[66:67] op_sel:[0,0] op_sel_hi:[0,1]
    v_pk_fma_f32 v[108:109], v[76:77], v[66:67], v[108:109] op_sel:[1,1,0] op_sel_hi:[1,0,1] neg_lo:[1,0,0]
    v_cvt_pk_bf16_f32 v197, v108, -v109
    v_pk_mul_f32 v[110:111], v[78:79], v[66:67] op_sel:[0,0] op_sel_hi:[0,1]
    v_pk_fma_f32 v[110:111], v[78:79], v[66:67], v[110:111] op_sel:[1,1,0] op_sel_hi:[1,0,1] neg_lo:[1,0,0]
    v_cvt_pk_bf16_f32 v198, v110, -v111
    v_pk_mul_f32 v[104:105], v[60:61], v[66:67] op_sel:[0,0] op_sel_hi:[0,1]
    v_pk_fma_f32 v[104:105], v[60:61], v[66:67], v[104:105] op_sel:[1,1,0] op_sel_hi:[1,0,1] neg_lo:[1,0,0]
    v_cvt_pk_bf16_f32 v199, v104, -v105
    ds_write_addtid_b32 v194 offset:6528
    ds_write_addtid_b32 v195 offset:9792
    ds_write_addtid_b32 v196 offset:10064
    ds_write_addtid_b32 v197 offset:10336
    ds_write_addtid_b32 v198 offset:10608
    ds_write_addtid_b32 v199 offset:11968
    s_add_u32 m0, s78, 32768
    s_nop 0
    buffer_load_dwordx4 v11, s[16:19], s79 offen offset:2048 lds
    s_mov_b32 m0, s81
    v_pk_mul_f32 v[106:107], v[82:83], v[66:67] op_sel:[0,0] op_sel_hi:[0,1]
    v_pk_fma_f32 v[106:107], v[82:83], v[66:67], v[106:107] op_sel:[1,1,0] op_sel_hi:[1,0,1] neg_lo:[1,0,0]
    v_cvt_pk_bf16_f32 v200, v106, -v107
    v_pk_mul_f32 v[108:109], v[68:69], v[66:67] op_sel:[0,0] op_sel_hi:[0,1]
    v_pk_fma_f32 v[108:109], v[68:69], v[66:67], v[108:109] op_sel:[1,1,0] op_sel_hi:[1,0,1] neg_lo:[1,0,0]
    v_cvt_pk_bf16_f32 v201, v108, -v109
    v_pk_mul_f32 v[110:111], v[70:71], v[66:67] op_sel:[0,0] op_sel_hi:[0,1]
    v_pk_fma_f32 v[110:111], v[70:71], v[66:67], v[110:111] op_sel:[1,1,0] op_sel_hi:[1,0,1] neg_lo:[1,0,0]
    v_cvt_pk_bf16_f32 v202, v110, -v111
    v_pk_mul_f32 v[104:105], v[60:61], v[72:73] op_sel:[0,0] op_sel_hi:[0,1]
    v_pk_fma_f32 v[104:105], v[60:61], v[72:73], v[104:105] op_sel:[1,1,0] op_sel_hi:[1,0,1] neg_lo:[1,0,0]
    v_cvt_pk_bf16_f32 v203, v104, -v105
    v_pk_mul_f32 v[106:107], v[68:69], v[72:73] op_sel:[0,0] op_sel_hi:[0,1]
    v_pk_fma_f32 v[106:107], v[68:69], v[72:73], v[106:107] op_sel:[1,1,0] op_sel_hi:[1,0,1] neg_lo:[1,0,0]
    v_cvt_pk_bf16_f32 v204, v106, -v107
    v_pk_mul_f32 v[108:109], v[70:71], v[72:73] op_sel:[0,0] op_sel_hi:[0,1]
    v_pk_fma_f32 v[108:109], v[70:71], v[72:73], v[108:109] op_sel:[1,1,0] op_sel_hi:[1,0,1] neg_lo:[1,0,0]
    v_cvt_pk_bf16_f32 v205, v108, -v109
    ds_write_addtid_b32 v200 offset:12240
    ds_write_addtid_b32 v201 offset:12512
    ds_write_addtid_b32 v202 offset:12784
    ds_write_addtid_b32 v203 offset:13328
    ds_write_addtid_b32 v204 offset:13600
    ds_write_addtid_b32 v205 offset:13872
    s_add_u32 m0, s78, 32768
    s_nop 0
    buffer_load_dwordx4 v12, s[16:19], s79 offen offset:3072 lds
    s_mov_b32 m0, s81
    v_pk_mul_f32 v[110:111], v[88:89], v[72:73] op_sel:[0,0] op_sel_hi:[0,1]
    v_pk_fma_f32 v[110:111], v[88:89], v[72:73], v[110:111] op_sel:[1,1,0] op_sel_hi:[1,0,1] neg_lo:[1,0,0]
    v_cvt_pk_bf16_f32 v206, v110, -v111
    v_pk_mul_f32 v[104:105], v[74:75], v[84:85] op_sel:[0,0] op_sel_hi:[0,1]
    v_pk_fma_f32 v[104:105], v[74:75], v[84:85], v[104:105] op_sel:[1,1,0] op_sel_hi:[1,0,1] neg_lo:[1,0,0]
    v_cvt_pk_bf16_f32 v207, v104, v105
    v_pk_mul_f32 v[106:107], v[54:55], v[84:85] op_sel:[0,0] op_sel_hi:[0,1]
    v_pk_fma_f32 v[106:107], v[54:55], v[84:85], v[106:107] op_sel:[1,1,0] op_sel_hi:[1,0,1] neg_lo:[1,0,0]
    v_cvt_pk_bf16_f32 v192, v106, v107
    v_pk_mul_f32 v[108:109], v[92:93], v[84:85] op_sel:[0,0] op_sel_hi:[0,1]
    v_pk_fma_f32 v[108:109], v[92:93], v[84:85], v[108:109] op_sel:[1,1,0] op_sel_hi:[1,0,1] neg_lo:[1,0,0]
    v_cvt_pk_bf16_f32 v193, v108, v109
    v_pk_mul_f32 v[110:111], v[80:81], v[84:85] op_sel:[0,0] op_sel_hi:[0,1]
    v_pk_fma_f32 v[110:111], v[80:81], v[84:85], v[110:111] op_sel:[1,1,0] op_sel_hi:[1,0,1] neg_lo:[1,0,0]
    v_cvt_pk_bf16_f32 v194, v110, v111
    v_pk_mul_f32 v[104:105], v[94:95], v[84:85] op_sel:[0,0] op_sel_hi:[0,1]
    v_pk_fma_f32 v[104:105], v[94:95], v[84:85], v[104:105] op_sel:[1,1,0] op_sel_hi:[1,0,1] neg_lo:[1,0,0]
    v_cvt_pk_bf16_f32 v195, v104, v105
    ds_write_addtid_b32 v206 offset:14144
    ds_write_addtid_b32 v207 offset:2448
    ds_write_addtid_b32 v192 offset:2720
    ds_write_addtid_b32 v193 offset:2992
    ds_write_addtid_b32 v194 offset:3264
    ds_write_addtid_b32 v195 offset:3536
    s_add_u32 m0, s78, 36864
    s_nop 0
    buffer_load_dwordx4 v9, s[20:23], s79 offen lds
    s_mov_b32 m0, s81
    buffer_load_dword v6, v26, s[12:15], s95 offen sc1
    v_pk_mul_f32 v[106:107], v[86:87], v[84:85] op_sel:[0,0] op_sel_hi:[0,1]
    v_pk_fma_f32 v[106:107], v[86:87], v[84:85], v[106:107] op_sel:[1,1,0] op_sel_hi:[1,0,1] neg_lo:[1,0,0]
    v_cvt_pk_bf16_f32 v196, v106, v107
    v_pk_mul_f32 v[108:109], v[96:97], v[84:85] op_sel:[0,0] op_sel_hi:[0,1]
    v_pk_fma_f32 v[108:109], v[96:97], v[84:85], v[108:109] op_sel:[1,1,0] op_sel_hi:[1,0,1] neg_lo:[1,0,0]
    v_cvt_pk_bf16_f32 v197, v108, v109
    v_pk_mul_f32 v[110:111], v[74:75], v[90:91] op_sel:[0,0] op_sel_hi:[0,1]
    v_pk_fma_f32 v[110:111], v[74:75], v[90:91], v[110:111] op_sel:[1,1,0] op_sel_hi:[1,0,1] neg_lo:[1,0,0]
    v_cvt_pk_bf16_f32 v198, v110, v111
    v_pk_mul_f32 v[104:105], v[54:55], v[90:91] op_sel:[0,0] op_sel_hi:[0,1]
    v_pk_fma_f32 v[104:105], v[54:55], v[90:91], v[104:105] op_sel:[1,1,0] op_sel_hi:[1,0,1] neg_lo:[1,0,0]
    v_cvt_pk_bf16_f32 v199, v104, v105
    v_pk_mul_f32 v[106:107], v[92:93], v[90:91] op_sel:[0,0] op_sel_hi:[0,1]
    v_pk_fma_f32 v[106:107], v[92:93], v[90:91], v[106:107] op_sel:[1,1,0] op_sel_hi:[1,0,1] neg_lo:[1,0,0]
    v_cvt_pk_bf16_f32 v200, v106, v107
    v_pk_mul_f32 v[108:109], v[80:81], v[90:91] op_sel:[0,0] op_sel_hi:[0,1]
    v_pk_fma_f32 v[108:109], v[80:81], v[90:91], v[108:109] op_sel:[1,1,0] op_sel_hi:[1,0,1] neg_lo:[1,0,0]
    v_cvt_pk_bf16_f32 v201, v108, v109
    ds_write_addtid_b32 v196 offset:3808
    ds_write_addtid_b32 v197 offset:4080
    ds_write_addtid_b32 v198 offset:4624
    ds_write_addtid_b32 v199 offset:4896
    ds_write_addtid_b32 v200 offset:5168
    ds_write_addtid_b32 v201 offset:5440
    s_add_u32 m0, s78, 36864
    s_nop 0
    buffer_load_dwordx4 v10, s[20:23], s79 offen offset:1024 lds
    s_mov_b32 m0, s81
    v_pk_mul_f32 v[110:111], v[94:95], v[90:91] op_sel:[0,0] op_sel_hi:[0,1]
    v_pk_fma_f32 v[110:111], v[94:95], v[90:91], v[110:111] op_sel:[1,1,0] op_sel_hi:[1,0,1] neg_lo:[1,0,0]
    v_cvt_pk_bf16_f32 v202, v110, v111
    v_pk_mul_f32 v[104:105], v[86:87], v[90:91] op_sel:[0,0] op_sel_hi:[0,1]
    v_pk_fma_f32 v[104:105], v[86:87], v[90:91], v[104:105] op_sel:[1,1,0] op_sel_hi:[1,0,1] neg_lo:[1,0,0]
    v_cvt_pk_bf16_f32 v203, v104, v105
    v_pk_mul_f32 v[106:107], v[96:97], v[90:91] op_sel:[0,0] op_sel_hi:[0,1]
    v_pk_fma_f32 v[106:107], v[96:97], v[90:91], v[106:107] op_sel:[1,1,0] op_sel_hi:[1,0,1] neg_lo:[1,0,0]
    v_cvt_pk_bf16_f32 v204, v106, v107
    v_pk_mul_f32 v[108:109], v[74:75], v[98:99] op_sel:[0,0] op_sel_hi:[0,1]
    v_pk_fma_f32 v[108:109], v[74:75], v[98:99], v[108:109] op_sel:[1,1,0] op_sel_hi:[1,0,1] neg_lo:[1,0,0]
    v_cvt_pk_bf16_f32 v205, v108, v109
    v_pk_mul_f32 v[110:111], v[54:55], v[98:99] op_sel:[0,0] op_sel_hi:[0,1]
    v_pk_fma_f32 v[110:111], v[54:55], v[98:99], v[110:111] op_sel:[1,1,0] op_sel_hi:[1,0,1] neg_lo:[1,0,0]
    v_cvt_pk_bf16_f32 v206, v110, v111
    v_pk_mul_f32 v[104:105], v[92:93], v[98:99] op_sel:[0,0] op_sel_hi:[0,1]
    v_pk_fma_f32 v[104:105], v[92:93], v[98:99], v[104:105] op_sel:[1,1,0] op_sel_hi:[1,0,1] neg_lo:[1,0,0]
    v_cvt_pk_bf16_f32 v207, v104, v105
    ds_write_addtid_b32 v202 offset:5712
    ds_write_addtid_b32 v203 offset:5984
    ds_write_addtid_b32 v204 offset:6256
    ds_write_addtid_b32 v205 offset:6800
    ds_write_addtid_b32 v206 offset:7072
    ds_write_addtid_b32 v207 offset:7344
    s_add_u32 m0, s78, 36864
    s_nop 0
    buffer_load_dwordx4 v11, s[20:23], s79 offen offset:2048 lds
    s_mov_b32 m0, s81
    v_pk_mul_f32 v[106:107], v[80:81], v[98:99] op_sel:[0,0] op_sel_hi:[0,1]
    v_pk_fma_f32 v[106:107], v[80:81], v[98:99], v[106:107] op_sel:[1,1,0] op_sel_hi:[1,0,1] neg_lo:[1,0,0]
    v_cvt_pk_bf16_f32 v192, v106, v107
    v_pk_mul_f32 v[108:109], v[94:95], v[98:99] op_sel:[0,0] op_sel_hi:[0,1]
    v_pk_fma_f32 v[108:109], v[94:95], v[98:99], v[108:109] op_sel:[1,1,0] op_sel_hi:[1,0,1] neg_lo:[1,0,0]
    v_cvt_pk_bf16_f32 v193, v108, v109
    v_pk_mul_f32 v[110:111], v[86:87], v[98:99] op_sel:[0,0] op_sel_hi:[0,1]
    v_pk_fma_f32 v[110:111], v[86:87], v[98:99], v[110:111] op_sel:[1,1,0] op_sel_hi:[1,0,1] neg_lo:[1,0,0]
    v_cvt_pk_bf16_f32 v194, v110, v111
    v_pk_mul_f32 v[104:105], v[96:97], v[98:99] op_sel:[0,0] op_sel_hi:[0,1]
    v_pk_fma_f32 v[104:105], v[96:97], v[98:99], v[104:105] op_sel:[1,1,0] op_sel_hi:[1,0,1] neg_lo:[1,0,0]
L_pad1:
    s_cbranch_execz L_early_back
    v_cvt_pk_bf16_f32 v195, v104, v105
    ds_write_addtid_b32 v192 offset:7616
    ds_write_addtid_b32 v193 offset:7888
    ds_write_addtid_b32 v194 offset:8160
    ds_write_addtid_b32 v195 offset:8432
    s_add_u32 m0, s78, 36864
    s_nop 0
    buffer_load_dwordx4 v12, s[20:23], s79 offen offset:3072 lds
    s_and_b32 m0, s81, 0x7fffffff
    ds_read_b128 v[112:115], v14 offset:8704
    ds_read_b128 v[116:119], v15 offset:0
    ds_read_b128 v[120:123], v14 offset:8736
    ds_read_b128 v[124:127], v15 offset:32
    ds_read_b128 v[128:131], v14 offset:8768
    ds_read_b128 v[132:135], v15 offset:64
    ds_read_b128 v[136:139], v14 offset:8800
    ds_read_b128 v[140:143], v15 offset:96
    ds_read_b128 v[144:147], v14 offset:8832
    ds_read_b128 v[148:151], v15 offset:128
    ds_read_b128 v[152:155], v14 offset:8864
    ds_read_b128 v[156:159], v15 offset:160
    ds_read_b128 v[160:163], v14 offset:8896
    ds_read_b128 v[164:167], v15 offset:192
    ds_read_b128 v[168:171], v14 offset:8928
    ds_read_b128 v[172:175], v15 offset:224
    s_waitcnt vmcnt(3)
    v_cmp_ne_u32 vcc, s32, v6
    s_cbranch_vccnz L_slow_1x
L_pdone_2:
    s_mov_b32 m0, s92
    s_mov_b32 s5, 0
    buffer_load_dwordx4 v27, s[12:15], s5 offen sc1 lds
    s_waitcnt lgkmcnt(14)
    v_mfma_f32_32x32x16_bf16 v[176:191], v[112:115], v[116:119], v[176:191]
    s_mov_b32 s5, 228352
    buffer_load_dwordx4 v27, s[12:15], s5 offen offset:1024 sc1 lds
    ds_read_b64_tr_b16 a[0:1], v13 offset:0
    ds_read_b64_tr_b16 a[2:3], v13 offset:256
    ds_read_b64_tr_b16 a[8:9], v13 offset:1024
    s_waitcnt lgkmcnt(14)
    v_mfma_f32_32x32x16_bf16 v[176:191], v[120:123], v[124:127], v[176:191]
    ds_read_b64_tr_b16 a[10:11], v13 offset:1280
    ds_read_b64_tr_b16 a[16:17], v13 offset:2048
    ds_read_b64_tr_b16 a[18:19], v13 offset:2304
    s_waitcnt lgkmcnt(14)
    v_mfma_f32_32x32x16_bf16 v[176:191], v[128:131], v[132:135], v[176:191]
    s_mov_b32 s5, 456704
    buffer_load_dwordx4 v27, s[12:15], s5 offen offset:2048 sc1 lds
    ds_read_b64_tr_b16 a[24:25], v13 offset:3072
    ds_read_b64_tr_b16 a[26:27], v13 offset:3328
    ds_read_b64_tr_b16 a[4:5], v13 offset:4096
    v_mfma_f32_32x32x16_bf16 v[176:191], v[136:139], v[140:143], v[176:191]
    ds_read_b64_tr_b16 a[6:7], v13 offset:4352
    ds_read_b64_tr_b16 a[12:13], v13 offset:5120
    ds_read_b64_tr_b16 a[14:15], v13 offset:5376
    s_waitcnt lgkmcnt(14)
    v_mfma_f32_32x32x16_bf16 v[176:191], v[144:147], v[148:151], v[176:191]
    s_mov_b32 s5, 685056
    buffer_load_dwordx4 v27, s[12:15], s5 offen offset:3072 sc1 lds
    ds_read_b64_tr_b16 a[20:21], v13 offset:6144
    ds_read_b64_tr_b16 a[22:23], v13 offset:6400
    ds_read_b64_tr_b16 a[28:29], v13 offset:7168
    v_mfma_f32_32x32x16_bf16 v[176:191], v[152:155], v[156:159], v[176:191]
    ds_read_b64_tr_b16 a[30:31], v13 offset:7424
    ds_read_b64_tr_b16 a[32:33], v13 offset:32768
    ds_read_b64_tr_b16 a[34:35], v13 offset:33024
    v_mfma_f32_32x32x16_bf16 v[176:191], v[160:163], v[164:167], v[176:191]
    ds_read_b64_tr_b16 a[40:41], v13 offset:33792
    ds_read_b64_tr_b16 a[42:43], v13 offset:34048
    ds_read_b64_tr_b16 a[48:49], v13 offset:34816
    s_waitcnt lgkmcnt(14)
    v_mfma_f32_32x32x16_bf16 v[176:191], v[168:171], v[172:175], v[176:191]
    ds_read_b64_tr_b16 a[50:51], v13 offset:35072
    ds_read_b64_tr_b16 a[56:57], v13 offset:35840
    ds_read_b64_tr_b16 a[58:59], v13 offset:36096
    s_waitcnt lgkmcnt(14)
    s_and_b32 m0, s78, 0x7fffffff
    s_mov_b32 s79, 458752
    buffer_load_dwordx4 v9, s[16:19], s79 offen lds
    s_lshl_b32 s74, s65, 16
    s_and_b32 s76, s65, 0xffff0000
    v_add_u32 v7, 8320, v38
    v_mov_b32 v2, 1
    s_nop 0
    ds_write2_b32 v16, v176, v177 offset0:0 offset1:1
    ds_write2_b32 v16, v178, v179 offset0:2 offset1:3
    ds_write_b32 v16, v180 offset:1056
    ds_write_b32 v16, v181 offset:1064
    ds_write_b32 v16, v182 offset:2112
    ds_write_b32 v16, v183 offset:3168
    ds_write_b32 v16, v184 offset:4224
    ds_write_b32 v16, v185 offset:5280
    ds_write_b32 v16, v186 offset:6336
    ds_write_b32 v16, v187 offset:7392
    buffer_load_dwordx4 v10, s[16:19], s79 offen offset:1024 lds
    s_waitcnt lgkmcnt(0)
    s_barrier
    ds_read2st64_b32 v[208:209], v17 offset0:0 offset1:57
    ds_read2st64_b32 v[210:211], v18 offset0:0 offset1:57
    ds_read2st64_b32 v[212:213], v19 offset0:0 offset1:57
    ds_read2st64_b32 v[214:215], v20 offset0:0 offset1:57
    ds_read2st64_b32 v[216:217], v21 offset0:0 offset1:57
    ds_read2st64_b32 v[218:219], v22 offset0:0 offset1:57
    ds_read2st64_b32 v[220:221], v23 offset0:0 offset1:57
    ds_read2st64_b32 v[222:223], v24 offset0:0 offset1:57
    ds_read2st64_b32 v[224:225], v25 offset0:0 offset1:57
    ds_read2st64_b32 v[226:227], v17 offset0:114 offset1:171
    ds_read2st64_b32 v[228:229], v18 offset0:114 offset1:171
    ds_read2st64_b32 v[230:231], v19 offset0:114 offset1:171
    ds_read2st64_b32 v[232:233], v20 offset0:114 offset1:171
    ds_read2st64_b32 v[234:235], v21 offset0:114 offset1:171
    ds_read2st64_b32 v[236:237], v22 offset0:114 offset1:171
    ds_read2st64_b32 v[238:239], v23 offset0:114 offset1:171
    ds_read2st64_b32 v[240:241], v24 offset0:114 offset1:171
    ds_read2st64_b32 v[242:243], v25 offset0:114 offset1:171
    buffer_load_dwordx4 v11, s[16:19], s79 offen offset:2048 lds
    v_and_b32 v4, 15, v1
    v_lshrrev_b32 v5, 4, v1
    v_lshrrev_b32 v6, 1, v5
    v_lshl_add_u32 v6, v4, 1, v6
    s_lshl_b32 s7, s4, 11
    s_add_u32 s7, s7, 77056
    v_lshl_add_u32 v6, v6, 6, s7
    v_bfe_u32 v4, v4, 1, 2
    v_and_b32_e64 v5, 1, v5
    v_lshl_add_u32 v247, v4, 4, v6
    v_lshl_add_u32 v36, v5, 3, v247
    v_xor_b32 v41, 16, v36
    v_or_b32 v5, 2, v5
    v_xor_b32_e64 v4, v4, v5
    v_lshl_add_u32 v37, v4, 4, v6
    buffer_load_dwordx4 v12, s[16:19], s79 offen offset:3072 lds
    s_waitcnt lgkmcnt(9)
    v_add_f32 v208, v208, v209
    v_add_f32 v210, v210, v211
    v_add_f32 v212, v212, v213
    v_add_f32 v214, v214, v215
    v_add_f32 v216, v216, v217
    v_add_f32 v218, v218, v219
    v_add_f32 v220, v220, v221
    v_add_f32 v222, v222, v223
    v_add_f32 v224, v224, v225
    v_cndmask_b32 v224, v224, 0, s[86:87]
    v_cvt_pk_bf16_f32 v192, v208, v210
    v_cvt_pk_bf16_f32 v193, v212, v214
    v_cvt_pk_bf16_f32 v194, v216, v218
    v_cvt_pk_bf16_f32 v195, v220, v222
    v_cvt_pk_bf16_f32 v196, v210, v212
    v_cvt_pk_bf16_f32 v197, v214, v216
    v_cvt_pk_bf16_f32 v198, v218, v220
    v_cvt_pk_bf16_f32 v199, v222, v224
    ds_write_b128 v38, v[192:195] offset:58368
    ds_write_b128 v38, v[196:199] offset:62528
    s_add_u32 m0, s78, 4096
    s_nop 0
    buffer_load_dwordx4 v9, s[20:23], s79 offen lds
    s_waitcnt lgkmcnt(2)
    v_add_f32 v226, v226, v227
    v_add_f32 v228, v228, v229
    v_add_f32 v230, v230, v231
    v_add_f32 v232, v232, v233
    v_add_f32 v234, v234, v235
    v_add_f32 v236, v236, v237
    v_add_f32 v238, v238, v239
    v_add_f32 v240, v240, v241
    v_add_f32 v242, v242, v243
    v_cndmask_b32 v242, v242, 0, s[86:87]
    v_cvt_pk_bf16_f32 v200, v226, v228
    v_cvt_pk_bf16_f32 v201, v230, v232
    v_cvt_pk_bf16_f32 v202, v234, v236
    v_cvt_pk_bf16_f32 v203, v238, v240
    v_cvt_pk_bf16_f32 v204, v228, v230
    v_cvt_pk_bf16_f32 v205, v232, v234
    v_cvt_pk_bf16_f32 v206, v236, v238
    v_cvt_pk_bf16_f32 v207, v240, v242
    ds_write_b128 v7, v[200:203] offset:58368
    ds_write_b128 v7, v[204:207] offset:62528
    buffer_load_dwordx4 v10, s[20:23], s79 offen offset:1024 lds
    s_waitcnt vmcnt(6)
    s_waitcnt lgkmcnt(0)
    s_barrier
    ds_read_b128 v[48:51], v32 offset:0
    ds_read2_b32 a[128:129], v28 offset0:176 offset1:177
    ds_read2_b32 a[130:131], v28 offset0:178 offset1:179
    ds_read_b128 v[52:55], v32 offset:2048
    ds_read2_b32 a[132:133], v28 offset0:48 offset1:49
    ds_read2_b32 a[134:135], v28 offset0:50 offset1:51
    ds_read_b128 v[56:59], v32 offset:4096
    ds_read2_b32 a[136:137], v29 offset0:176 offset1:177
    ds_read2_b32 a[138:139], v29 offset0:178 offset1:179
    ds_read_b128 v[60:63], v32 offset:6144
    ds_read2_b32 a[140:141], v29 offset0:48 offset1:49
    ds_read2_b32 a[142:143], v29 offset0:50 offset1:51
    ds_read_b128 v[80:83], v33 offset:0
    ds_read2_b32 a[160:161], v28 offset0:160 offset1:161
    ds_read2_b32 a[162:163], v28 offset0:162 offset1:163
    buffer_load_dwordx4 v11, s[20:23], s79 offen offset:2048 lds
    buffer_load_dwordx4 v12, s[20:23], s79 offen offset:3072 lds
    s_waitcnt lgkmcnt(12)
    v_mfma_f32_16x16x32_bf16 v[176:179], a[128:131], v[48:51], 0
    ds_read_b128 v[84:87], v33 offset:2048
    ds_read2_b32 a[164:165], v28 offset0:32 offset1:33
    s_waitcnt lgkmcnt(13)
    v_mfma_f32_16x16x32_bf16 v[180:183], a[128:131], v[52:55], 0
    ds_read2_b32 a[166:167], v28 offset0:34 offset1:35
    s_waitcnt lgkmcnt(12)
    v_mfma_f32_16x16x32_bf16 v[180:183], a[132:135], v[48:51], v[180:183]
    ds_read_b128 v[88:91], v33 offset:4096
    ds_read2_b32 a[168:169], v29 offset0:160 offset1:161
    v_mfma_f32_16x16x32_bf16 v[184:187], a[132:135], v[52:55], 0
    ds_read2_b32 a[170:171], v29 offset0:162 offset1:163
    s_waitcnt lgkmcnt(14)
    v_mfma_f32_16x16x32_bf16 v[184:187], a[128:131], v[56:59], v[184:187]
    ds_read_b128 v[92:95], v33 offset:6144
    ds_read2_b32 a[172:173], v29 offset0:32 offset1:33
    v_mfma_f32_16x16x32_bf16 v[188:191], a[132:135], v[56:59], 0
    ds_read2_b32 a[174:175], v29 offset0:34 offset1:35
    s_waitcnt lgkmcnt(14)
    v_mfma_f32_16x16x32_bf16 v[184:187], a[136:139], v[48:51], v[184:187]
    ds_read_b128 v[112:115], v34 offset:0
    ds_read2_b32 a[192:193], v28 offset0:144 offset1:145
    v_mfma_f32_16x16x32_bf16 v[188:191], a[136:139], v[52:55], v[188:191]
    ds_read2_b32 a[194:195], v28 offset0:146 offset1:147
    v_mfma_f32_16x16x32_bf16 v[188:191], a[128:131], v[60:63], v[188:191]
    ds_read_b128 v[116:119], v34 offset:2048
    ds_read2_b32 a[196:197], v28 offset0:16 offset1:17
    s_waitcnt lgkmcnt(14)
    v_mfma_f32_16x16x32_bf16 v[188:191], a[140:143], v[48:51], v[188:191]
    ds_read2_b32 a[198:199], v28 offset0:18 offset1:19
    v_mfma_f32_16x16x32_bf16 v[176:179], a[160:163], v[80:83], v[176:179]
    ds_read_b128 v[120:123], v34 offset:4096
    ds_read2_b32 a[200:201], v29 offset0:144 offset1:145
    s_waitcnt lgkmcnt(14)
    v_mfma_f32_16x16x32_bf16 v[180:183], a[160:163], v[84:87], v[180:183]
    ds_read2_b32 a[202:203], v29 offset0:146 offset1:147
    v_mfma_f32_16x16x32_bf16 v[180:183], a[164:167], v[80:83], v[180:183]
    ds_read_b128 v[124:127], v34 offset:6144
    ds_read2_b32 a[204:205], v29 offset0:16 offset1:17
    v_mfma_f32_16x16x32_bf16 v[184:187], a[164:167], v[84:87], v[184:187]
    ds_read2_b32 a[206:207], v29 offset0:18 offset1:19
    s_waitcnt lgkmcnt(14)
    v_mfma_f32_16x16x32_bf16 v[184:187], a[160:163], v[88:91], v[184:187]
    ds_read_b128 v[144:147], v35 offset:0
    ds_read2_b32 a[224:225], v28 offset0:128 offset1:129
    v_mfma_f32_16x16x32_bf16 v[188:191], a[164:167], v[88:91], v[188:191]
    ds_read2_b32 a[226:227], v28 offset0:130 offset1:131
    v_mfma_f32_16x16x32_bf16 v[184:187], a[168:171], v[80:83], v[184:187]
    ds_read_b128 v[148:151], v35 offset:2048
    ds_read2_b32 a[228:229], v28 offset0:0 offset1:1
    v_mfma_f32_16x16x32_bf16 v[188:191], a[168:171], v[84:87], v[188:191]
    ds_read2_b32 a[230:231], v28 offset0:2 offset1:3
    v_mfma_f32_16x16x32_bf16 v[188:191], a[160:163], v[92:95], v[188:191]
    ds_read_b128 v[152:155], v35 offset:4096
    ds_read2_b32 a[232:233], v29 offset0:128 offset1:129
    s_waitcnt lgkmcnt(14)
    v_mfma_f32_16x16x32_bf16 v[188:191], a[172:175], v[80:83], v[188:191]
    ds_read2_b32 a[234:235], v29 offset0:130 offset1:131
    v_mfma_f32_16x16x32_bf16 v[176:179], a[192:195], v[112:115], v[176:179]
    ds_read_b128 v[156:159], v35 offset:6144
    ds_read2_b32 a[236:237], v29 offset0:0 offset1:1
    v_mfma_f32_16x16x32_bf16 v[180:183], a[192:195], v[116:119], v[180:183]
    ds_read2_b32 a[238:239], v29 offset0:2 offset1:3
    v_mfma_f32_16x16x32_bf16 v[180:183], a[196:199], v[112:115], v[180:183]
    ds_read_b64 v[208:209], v36 offset:0
    ds_read_b64 v[210:211], v41 offset:0
    v_mfma_f32_16x16x32_bf16 v[184:187], a[196:199], v[116:119], v[184:187]
    ds_read_b128 v[212:215], v37 offset:0
    s_waitcnt lgkmcnt(14)
    v_mfma_f32_16x16x32_bf16 v[184:187], a[192:195], v[120:123], v[184:187]
    v_mfma_f32_16x16x32_bf16 v[188:191], a[196:199], v[120:123], v[188:191]
    v_mfma_f32_16x16x32_bf16 v[184:187], a[200:203], v[112:115], v[184:187]
    v_mfma_f32_16x16x32_bf16 v[188:191], a[200:203], v[116:119], v[188:191]
    v_mfma_f32_16x16x32_bf16 v[188:191], a[192:195], v[124:127], v[188:191]
    v_mfma_f32_16x16x32_bf16 v[188:191], a[204:207], v[112:115], v[188:191]
    s_waitcnt lgkmcnt(0)
    v_lshlrev_b32 v232, 16, v212
    v_and_b32 v236, 0xffff0000, v212
    v_mfma_f32_16x16x32_bf16 v[176:179], a[224:227], v[144:147], v[176:179]
    v_lshlrev_b32_e64 v233, 16, v213
    v_and_b32 v237, 0xffff0000, v213
    v_mfma_f32_16x16x32_bf16 v[180:183], a[224:227], v[148:151], v[180:183]
    v_lshlrev_b32_e64 v234, 16, v214
    v_and_b32 v238, 0xffff0000, v214
    v_mfma_f32_16x16x32_bf16 v[180:183], a[228:231], v[144:147], v[180:183]
    v_lshlrev_b32_e64 v235, 16, v215
    v_and_b32 v239, 0xffff0000, v215
    v_mfma_f32_16x16x32_bf16 v[184:187], a[224:227], v[152:155], v[184:187]
    ds_write_b128 v38, v[176:179] offset:0
    v_lshlrev_b32_e64 v240, 16, v208
    v_mfma_f32_16x16x32_bf16 v[184:187], a[228:231], v[148:151], v[184:187]
    v_and_b32 v241, 0xffff0000, v208
    v_fmac_f32_e64 v232, s74, v240
    v_mfma_f32_16x16x32_bf16 v[184:187], a[232:235], v[144:147], v[184:187]
    ds_write_b128 v38, v[180:183] offset:7168
    v_fmac_f32_e64 v233, s74, v241
    v_mfma_f32_16x16x32_bf16 v[188:191], a[224:227], v[156:159], v[188:191]
    v_lshlrev_b32_e64 v240, 16, v209
    v_and_b32 v241, 0xffff0000, v209
    v_mfma_f32_16x16x32_bf16 v[188:191], a[228:231], v[152:155], v[188:191]
    v_fmac_f32 v234, s74, v240
    v_fmac_f32 v235, s74, v241
    v_mfma_f32_16x16x32_bf16 v[188:191], a[232:235], v[148:151], v[188:191]
    ds_write_b128 v38, v[184:187] offset:14336
    v_lshlrev_b32_e64 v240, 16, v210
    v_mfma_f32_16x16x32_bf16 v[188:191], a[236:239], v[144:147], v[188:191]
    v_and_b32 v241, 0xffff0000, v210
    v_fmac_f32_e64 v236, s76, v240
    v_mfma_f32_16x16x32_bf16 v[192:195], a[136:139], v[56:59], 0
    v_fmac_f32 v237, s76, v241
    v_lshlrev_b32 v240, 16, v211
    v_mfma_f32_16x16x32_bf16 v[192:195], a[132:135], v[60:63], v[192:195]
    v_and_b32 v241, 0xffff0000, v211
    v_fmac_f32_e64 v238, s76, v240
    v_mfma_f32_16x16x32_bf16 v[196:199], a[136:139], v[60:63], 0
    ds_write_b128 v38, v[188:191] offset:21504
    v_fmac_f32_e64 v239, s76, v241
    v_mfma_f32_16x16x32_bf16 v[192:195], a[140:143], v[52:55], v[192:195]
    v_mfma_f32_16x16x32_bf16 v[196:199], a[140:143], v[56:59], v[196:199]
    v_mfma_f32_16x16x32_bf16 v[200:203], a[140:143], v[60:63], 0
    s_waitcnt lgkmcnt(0)
    s_barrier
    v_mfma_f32_16x16x32_bf16 v[192:195], a[168:171], v[88:91], v[192:195]
    ds_read_b128 v[216:219], v39 offset:0
    ds_read_b128 v[220:223], v39 offset:1024
    ds_read_b128 v[224:227], v39 offset:2048
    ds_read_b128 v[228:231], v39 offset:3072
    v_mfma_f32_16x16x32_bf16 v[192:195], a[164:167], v[92:95], v[192:195]
    s_add_u32 m0, s78, 32768
    s_mov_b32 s79, 688128
    buffer_load_dwordx4 v9, s[16:19], s79 offen lds
    v_mfma_f32_16x16x32_bf16 v[196:199], a[168:171], v[92:95], v[196:199]
    v_mfma_f32_16x16x32_bf16 v[192:195], a[172:175], v[84:87], v[192:195]
    v_mfma_f32_16x16x32_bf16 v[196:199], a[172:175], v[88:91], v[196:199]
    buffer_load_dwordx4 v10, s[16:19], s79 offen offset:1024 lds
    v_mfma_f32_16x16x32_bf16 v[200:203], a[172:175], v[92:95], v[200:203]
    v_mfma_f32_16x16x32_bf16 v[192:195], a[200:203], v[120:123], v[192:195]
    v_mfma_f32_16x16x32_bf16 v[192:195], a[196:199], v[124:127], v[192:195]
    v_mfma_f32_16x16x32_bf16 v[196:199], a[200:203], v[124:127], v[196:199]
    s_waitcnt lgkmcnt(3)
    v_pk_add_f32 v[232:233], v[232:233], v[216:217]
    v_pk_add_f32 v[234:235], v[234:235], v[218:219]
    s_waitcnt lgkmcnt(2)
    v_pk_add_f32 v[232:233], v[232:233], v[220:221]
    v_pk_add_f32 v[234:235], v[234:235], v[222:223]
    s_waitcnt lgkmcnt(1)
    v_pk_add_f32 v[236:237], v[236:237], v[224:225]
    v_pk_add_f32 v[238:239], v[238:239], v[226:227]
    s_waitcnt lgkmcnt(0)
    v_pk_add_f32 v[236:237], v[236:237], v[228:229]
    v_pk_add_f32 v[238:239], v[238:239], v[230:231]
    v_cvt_pk_bf16_f32 v244, v232, v236
    v_cvt_pk_bf16_f32 v245, v233, v237
    v_cvt_pk_bf16_f32 v246, v234, v238
    v_cvt_pk_bf16_f32 v247, v235, v239
    buffer_store_dwordx4 v[244:247], v38, s[12:15], s43 offen sc1
    ds_read_b128 v[64:67], v32 offset:8192
    ds_read_b128 v[68:71], v32 offset:10240
    ds_read_b128 v[72:75], v32 offset:12288
    ds_read_b128 v[76:79], v32 offset:14336
    ds_read2_b32 a[144:145], v30 offset0:176 offset1:177
    ds_read2_b32 a[146:147], v30 offset0:178 offset1:179
    ds_read2_b32 a[148:149], v30 offset0:48 offset1:49
    ds_read2_b32 a[150:151], v30 offset0:50 offset1:51
    v_mfma_f32_16x16x32_bf16 v[192:195], a[204:207], v[116:119], v[192:195]
    ds_read2_b32 a[152:153], v31 offset0:176 offset1:177
    ds_read_b64_tr_b16 a[36:37], v13 offset:36864
    v_mfma_f32_16x16x32_bf16 v[196:199], a[204:207], v[120:123], v[196:199]
    ds_read2_b32 a[154:155], v31 offset0:178 offset1:179
    ds_read_b64_tr_b16 a[38:39], v13 offset:37120
    buffer_load_dwordx4 v11, s[16:19], s79 offen offset:2048 lds
    v_mfma_f32_16x16x32_bf16 v[200:203], a[204:207], v[124:127], v[200:203]
    ds_read2_b32 a[156:157], v31 offset0:48 offset1:49
    ds_read_b64_tr_b16 a[44:45], v13 offset:37888
    v_mfma_f32_16x16x32_bf16 v[192:195], a[228:231], v[156:159], v[192:195]
    ds_read2_b32 a[158:159], v31 offset0:50 offset1:51
    ds_read_b64_tr_b16 a[46:47], v13 offset:38144
    v_mfma_f32_16x16x32_bf16 v[192:195], a[232:235], v[152:155], v[192:195]
    ds_read_b128 v[96:99], v33 offset:8192
    ds_read_b64_tr_b16 a[52:53], v13 offset:38912
    buffer_load_dwordx4 v12, s[16:19], s79 offen offset:3072 lds
    v_mfma_f32_16x16x32_bf16 v[192:195], a[236:239], v[148:151], v[192:195]
    ds_read_b128 v[100:103], v33 offset:10240
    ds_read_b64_tr_b16 a[54:55], v13 offset:39168
    v_mfma_f32_16x16x32_bf16 v[196:199], a[232:235], v[156:159], v[196:199]
    ds_read_b128 v[104:107], v33 offset:12288
    ds_read_b64_tr_b16 a[60:61], v13 offset:39936
    v_mfma_f32_16x16x32_bf16 v[196:199], a[236:239], v[152:155], v[196:199]
    ds_read_b128 v[108:111], v33 offset:14336
    ds_read_b64_tr_b16 a[62:63], v13 offset:40192
    v_mfma_f32_16x16x32_bf16 v[200:203], a[236:239], v[156:159], v[200:203]
    ds_read2_b32 a[176:177], v30 offset0:160 offset1:161
    s_waitcnt lgkmcnt(1)
    s_add_u32 m0, s78, 36864
    s_nop 0
    buffer_load_dwordx4 v9, s[20:23], s79 offen lds
    v_mfma_f32_16x16x32_bf16 v[192:195], a[128:131], v[64:67], v[192:195]
    ds_read2_b32 a[178:179], v30 offset0:162 offset1:163
    v_mfma_f32_16x16x32_bf16 v[196:199], a[132:135], v[64:67], v[196:199]
    ds_read2_b32 a[180:181], v30 offset0:32 offset1:33
    v_mfma_f32_16x16x32_bf16 v[200:203], a[136:139], v[64:67], v[200:203]
    ds_read2_b32 a[182:183], v30 offset0:34 offset1:35
    buffer_load_dwordx4 v10, s[20:23], s79 offen offset:1024 lds
    v_mfma_f32_16x16x32_bf16 v[204:207], a[140:143], v[64:67], 0
    ds_read2_b32 a[184:185], v31 offset0:160 offset1:161
    s_waitcnt vmcnt(11)
    v_mfma_f32_16x16x32_bf16 v[192:195], a[144:147], v[48:51], v[192:195]
    ds_read2_b32 a[186:187], v31 offset0:162 offset1:163
    ds_read_b64_tr_b16 a[64:65], v13 offset:0
    v_mfma_f32_16x16x32_bf16 v[196:199], a[144:147], v[52:55], v[196:199]
    ds_read2_b32 a[188:189], v31 offset0:32 offset1:33
    ds_read_b64_tr_b16 a[66:67], v13 offset:256
    v_mfma_f32_16x16x32_bf16 v[200:203], a[144:147], v[56:59], v[200:203]
    ds_read2_b32 a[190:191], v31 offset0:34 offset1:35
    buffer_load_dwordx4 v11, s[20:23], s79 offen offset:2048 lds
    ds_read_b64_tr_b16 a[72:73], v13 offset:1024
    v_mfma_f32_16x16x32_bf16 v[204:207], a[144:147], v[60:63], v[204:207]
    ds_read_b128 v[128:131], v34 offset:8192
    ds_read_b64_tr_b16 a[74:75], v13 offset:1280
    v_mfma_f32_16x16x32_bf16 v[196:199], a[128:131], v[68:71], v[196:199]
    ds_read_b128 v[132:135], v34 offset:10240
    ds_read_b64_tr_b16 a[80:81], v13 offset:2048
    v_mfma_f32_16x16x32_bf16 v[200:203], a[132:135], v[68:71], v[200:203]
    ds_read_b128 v[136:139], v34 offset:12288
    buffer_load_dwordx4 v12, s[20:23], s79 offen offset:3072 lds
    ds_read_b64_tr_b16 a[82:83], v13 offset:2304
    v_mfma_f32_16x16x32_bf16 v[204:207], a[136:139], v[68:71], v[204:207]
    ds_read_b128 v[140:143], v34 offset:14336
    ds_read_b64_tr_b16 a[88:89], v13 offset:3072
    v_mfma_f32_16x16x32_bf16 v[196:199], a[148:151], v[48:51], v[196:199]
    ds_read2_b32 a[208:209], v30 offset0:144 offset1:145
    ds_read_b64_tr_b16 a[90:91], v13 offset:3328
    v_mfma_f32_16x16x32_bf16 v[200:203], a[148:151], v[52:55], v[200:203]
    ds_read2_b32 a[210:211], v30 offset0:146 offset1:147
    v_mfma_f32_16x16x32_bf16 v[204:207], a[148:151], v[56:59], v[204:207]
    ds_read2_b32 a[212:213], v30 offset0:16 offset1:17
    v_mfma_f32_16x16x32_bf16 v[200:203], a[128:131], v[72:75], v[200:203]
    ds_read2_b32 a[214:215], v30 offset0:18 offset1:19
    v_mfma_f32_16x16x32_bf16 v[204:207], a[132:135], v[72:75], v[204:207]
    ds_read2_b32 a[216:217], v31 offset0:144 offset1:145
    s_waitcnt vmcnt(6)
    buffer_atomic_add v2, v40, s[12:15], s84 offen
    s_add_u32 s84, s84, 0x8000
    v_mfma_f32_16x16x32_bf16 v[200:203], a[152:155], v[48:51], v[200:203]
    ds_read2_b32 a[218:219], v31 offset0:146 offset1:147
    ds_read_b64_tr_b16 a[68:69], v13 offset:4096
    v_mfma_f32_16x16x32_bf16 v[204:207], a[152:155], v[52:55], v[204:207]
    ds_read2_b32 a[220:221], v31 offset0:16 offset1:17
    ds_read_b64_tr_b16 a[70:71], v13 offset:4352
    v_mfma_f32_16x16x32_bf16 v[204:207], a[128:131], v[76:79], v[204:207]
    ds_read2_b32 a[222:223], v31 offset0:18 offset1:19
    ds_read_b64_tr_b16 a[76:77], v13 offset:5120
    v_mfma_f32_16x16x32_bf16 v[204:207], a[156:159], v[48:51], v[204:207]
    ds_read_b128 v[160:163], v35 offset:8192
    ds_read_b64_tr_b16 a[78:79], v13 offset:5376
    v_mfma_f32_16x16x32_bf16 v[192:195], a[160:163], v[96:99], v[192:195]
    ds_read_b128 v[164:167], v35 offset:10240
    ds_read_b64_tr_b16 a[84:85], v13 offset:6144
    v_mfma_f32_16x16x32_bf16 v[196:199], a[164:167], v[96:99], v[196:199]
    ds_read_b128 v[168:171], v35 offset:12288
    ds_read_b64_tr_b16 a[86:87], v13 offset:6400
    s_waitcnt lgkmcnt(14)
    s_add_u32 m0, s78, 0
    s_mov_b32 s79, 917504
    buffer_load_dwordx4 v9, s[16:19], s79 offen lds
    v_mfma_f32_16x16x32_bf16 v[200:203], a[168:171], v[96:99], v[200:203]
    ds_read_b128 v[172:175], v35 offset:14336
    ds_read_b64_tr_b16 a[92:93], v13 offset:7168
    v_mfma_f32_16x16x32_bf16 v[204:207], a[172:175], v[96:99], v[204:207]
    ds_read2_b32 a[240:241], v30 offset0:128 offset1:129
    ds_read_b64_tr_b16 a[94:95], v13 offset:7424
    v_mfma_f32_16x16x32_bf16 v[192:195], a[176:179], v[80:83], v[192:195]
    ds_read2_b32 a[242:243], v30 offset0:130 offset1:131
    buffer_load_dwordx4 v10, s[16:19], s79 offen offset:1024 lds
    v_mfma_f32_16x16x32_bf16 v[196:199], a[176:179], v[84:87], v[196:199]
    ds_read2_b32 a[244:245], v30 offset0:0 offset1:1
    v_add_u32 v38, 58368, v38
    v_mfma_f32_16x16x32_bf16 v[200:203], a[176:179], v[88:91], v[200:203]
    ds_read2_b32 a[246:247], v30 offset0:2 offset1:3
    s_lshl_b32 s5, s4, 12
    v_mfma_f32_16x16x32_bf16 v[204:207], a[176:179], v[92:95], v[204:207]
    ds_read2_b32 a[248:249], v31 offset0:128 offset1:129
    buffer_load_dwordx4 v11, s[16:19], s79 offen offset:2048 lds
    v_mfma_f32_16x16x32_bf16 v[196:199], a[160:163], v[100:103], v[196:199]
    ds_read2_b32 a[250:251], v31 offset0:130 offset1:131
    s_add_u32 s5, s5, 58368
    v_mfma_f32_16x16x32_bf16 v[200:203], a[164:167], v[100:103], v[200:203]
    ds_read2_b32 a[252:253], v31 offset0:0 offset1:1
    v_add_u32 v39, s5, v3
    v_mfma_f32_16x16x32_bf16 v[204:207], a[168:171], v[100:103], v[204:207]
    ds_read2_b32 a[254:255], v31 offset0:2 offset1:3
    buffer_load_dwordx4 v12, s[16:19], s79 offen offset:3072 lds
    v_mfma_f32_16x16x32_bf16 v[196:199], a[180:183], v[80:83], v[196:199]
    s_add_u32 s43, s43, 916480
    v_bfe_u32 v4, v1, 3, 1
    v_mfma_f32_16x16x32_bf16 v[200:203], a[180:183], v[84:87], v[200:203]
    ds_read_b64 v[208:209], v36 offset:8192
    v_lshrrev_b32 v5, 5, v1
    v_mfma_f32_16x16x32_bf16 v[204:207], a[180:183], v[88:91], v[204:207]
    s_waitcnt lgkmcnt(8)
    s_add_u32 m0, s78, 4096
    s_nop 0
    buffer_load_dwordx4 v9, s[20:23], s79 offen lds
    ds_read_b64 v[210:211], v41 offset:8192
    v_mfma_f32_16x16x32_bf16 v[200:203], a[160:163], v[104:107], v[200:203]
    ds_read_b128 v[212:215], v37 offset:8192
    v_lshl_add_u32 v4, v5, 1, v4
    v_mfma_f32_16x16x32_bf16 v[204:207], a[164:167], v[104:107], v[204:207]
    s_waitcnt vmcnt(10)
    v_and_b32 v5, 0x70, v3
    v_mfma_f32_16x16x32_bf16 v[200:203], a[184:187], v[80:83], v[200:203]
    ds_read_b64_tr_b16 a[96:97], v13 offset:32768
    buffer_load_dwordx4 v10, s[20:23], s79 offen offset:1024 lds
    v_mfma_f32_16x16x32_bf16 v[204:207], a[184:187], v[84:87], v[204:207]
    ds_read_b64_tr_b16 a[98:99], v13 offset:33024
    v_lshlrev_b32_e64 v6, 5, v4
    v_mfma_f32_16x16x32_bf16 v[204:207], a[160:163], v[108:111], v[204:207]
    ds_read_b64_tr_b16 a[104:105], v13 offset:33792
    v_xor_b32_e64 v5, v5, v6
    v_mfma_f32_16x16x32_bf16 v[204:207], a[188:191], v[80:83], v[204:207]
    ds_read_b64_tr_b16 a[106:107], v13 offset:34048
    buffer_load_dwordx4 v11, s[20:23], s79 offen offset:2048 lds
    v_mfma_f32_16x16x32_bf16 v[192:195], a[192:195], v[128:131], v[192:195]
    ds_read_b64_tr_b16 a[112:113], v13 offset:34816
    v_bfe_u32 v6, v1, 4, 1
    v_mfma_f32_16x16x32_bf16 v[196:199], a[196:199], v[128:131], v[196:199]
    ds_read_b64_tr_b16 a[114:115], v13 offset:35072
    v_lshl_add_u32 v4, v4, 1, v6
    v_mfma_f32_16x16x32_bf16 v[200:203], a[200:203], v[128:131], v[200:203]
    ds_read_b64_tr_b16 a[120:121], v13 offset:35840
    buffer_load_dwordx4 v12, s[20:23], s79 offen offset:3072 lds
    v_mfma_f32_16x16x32_bf16 v[204:207], a[204:207], v[128:131], v[204:207]
    ds_read_b64_tr_b16 a[122:123], v13 offset:36096
    v_mul_u32_u24 v4, 4352, v4
    v_mfma_f32_16x16x32_bf16 v[192:195], a[208:211], v[112:115], v[192:195]
    v_add3_u32 v17, v4, v5, s44
    v_add_u32 v18, 33792, v17
    v_mfma_f32_16x16x32_bf16 v[196:199], a[208:211], v[116:119], v[196:199]
    s_waitcnt lgkmcnt(11)
    s_barrier
    v_mfma_f32_16x16x32_bf16 v[200:203], a[208:211], v[120:123], v[200:203]
    v_add_u32 v19, 67584, v17
    v_add_u32 v20, 101376, v17
    v_mfma_f32_16x16x32_bf16 v[204:207], a[208:211], v[124:127], v[204:207]
    s_waitcnt lgkmcnt(0)
    s_add_u32 m0, s78, 32768
    s_mov_b32 s79, 1146880
    buffer_load_dwordx4 v9, s[16:19], s79 offen lds
    v_mfma_f32_16x16x32_bf16 v[196:199], a[192:195], v[132:135], v[196:199]
    v_bfe_u32 v4, v1, 2, 2
    v_bfe_u32 v5, v1, 4, 1
    v_mfma_f32_16x16x32_bf16 v[200:203], a[196:199], v[132:135], v[200:203]
    v_mov_b32 v7, 0
    buffer_atomic_add v7, v43, s[12:15], s40 offen sc0
    v_mov_b32 v6, 0x3f803f80
    v_cmp_eq_u32 vcc, v4, v5
    v_mfma_f32_16x16x32_bf16 v[204:207], a[200:203], v[132:135], v[204:207]
L_pad2:
    s_cbranch_execz L_early_back
    buffer_load_dwordx4 v10, s[16:19], s79 offen offset:1024 lds
    v_mfma_f32_16x16x32_bf16 v[196:199], a[212:215], v[112:115], v[196:199]
    s_waitcnt vmcnt(12)
    v_cndmask_b32 v176, 0, v6, vcc
    v_mfma_f32_16x16x32_bf16 v[200:203], a[212:215], v[116:119], v[200:203]
    ds_read_b64_tr_b16 a[100:101], v13 offset:36864
    v_cndmask_b32_e64 v177, 0, v6, vcc
    v_mfma_f32_16x16x32_bf16 v[204:207], a[212:215], v[120:123], v[204:207]
    ds_read_b64_tr_b16 a[102:103], v13 offset:37120
    buffer_load_dwordx4 v11, s[16:19], s79 offen offset:2048 lds
    v_mfma_f32_16x16x32_bf16 v[200:203], a[192:195], v[136:139], v[200:203]
    ds_read_b64_tr_b16 a[108:109], v13 offset:37888
    v_cndmask_b32_e64 v178, 0, v6, vcc
    v_mfma_f32_16x16x32_bf16 v[204:207], a[196:199], v[136:139], v[204:207]
    ds_read_b64_tr_b16 a[110:111], v13 offset:38144
    v_cndmask_b32_e64 v179, 0, v6, vcc
    v_mfma_f32_16x16x32_bf16 v[200:203], a[216:219], v[112:115], v[200:203]
    ds_read_b64_tr_b16 a[116:117], v13 offset:38912
    buffer_load_dwordx4 v12, s[16:19], s79 offen offset:3072 lds
    v_mfma_f32_16x16x32_bf16 v[204:207], a[216:219], v[116:119], v[204:207]
    ds_read_b64_tr_b16 a[118:119], v13 offset:39168
    v_lshlrev_b32_e64 v232, 16, v212
    v_mfma_f32_16x16x32_bf16 v[204:207], a[192:195], v[140:143], v[204:207]
    ds_read_b64_tr_b16 a[124:125], v13 offset:39936
    v_and_b32 v236, 0xffff0000, v212
    v_mfma_f32_16x16x32_bf16 v[204:207], a[220:223], v[112:115], v[204:207]
    ds_read_b64_tr_b16 a[126:127], v13 offset:40192
    v_lshlrev_b32_e64 v233, 16, v213
    v_mfma_f32_16x16x32_bf16 v[192:195], a[224:227], v[160:163], v[192:195]
    v_and_b32 v237, 0xffff0000, v213
    v_lshlrev_b32_e64 v234, 16, v214
    v_mfma_f32_16x16x32_bf16 v[192:195], a[240:243], v[144:147], v[192:195]
    v_and_b32 v238, 0xffff0000, v214
    v_lshlrev_b32_e64 v235, 16, v215
    v_mfma_f32_16x16x32_bf16 v[196:199], a[224:227], v[164:167], v[196:199]
    s_waitcnt lgkmcnt(0)
    s_add_u32 m0, s78, 36864
    s_nop 0
    buffer_load_dwordx4 v9, s[20:23], s79 offen lds
    v_mfma_f32_16x16x32_bf16 v[196:199], a[228:231], v[160:163], v[196:199]
    v_mov_b32_e64 v23, 0
    buffer_atomic_add v23, v43, s[12:15], s40 offen sc0
    v_and_b32 v239, 0xffff0000, v215
    v_lshlrev_b32_e64 v240, 16, v208
    v_mfma_f32_16x16x32_bf16 v[196:199], a[240:243], v[148:151], v[196:199]
    buffer_load_dwordx4 v10, s[20:23], s79 offen offset:1024 lds
    v_mfma_f32_16x16x32_bf16 v[196:199], a[244:247], v[144:147], v[196:199]
    ds_write_b128 v38, v[192:195] offset:0
    v_and_b32 v241, 0xffff0000, v208
    v_fmac_f32_e64 v232, s74, v240
    v_mfma_f32_16x16x32_bf16 v[200:203], a[224:227], v[168:171], v[200:203]
    v_fmac_f32 v233, s74, v241
    v_lshlrev_b32 v240, 16, v209
    v_mfma_f32_16x16x32_bf16 v[200:203], a[228:231], v[164:167], v[200:203]
    buffer_load_dwordx4 v11, s[20:23], s79 offen offset:2048 lds
    v_mfma_f32_16x16x32_bf16 v[200:203], a[232:235], v[160:163], v[200:203]
    v_and_b32 v241, 0xffff0000, v209
    v_fmac_f32_e64 v234, s74, v240
    v_mfma_f32_16x16x32_bf16 v[200:203], a[240:243], v[152:155], v[200:203]
    buffer_load_dwordx4 v12, s[20:23], s79 offen offset:3072 lds
    ds_write_b128 v38, v[196:199] offset:4096
    v_mfma_f32_16x16x32_bf16 v[200:203], a[244:247], v[148:151], v[200:203]
    v_fmac_f32 v235, s74, v241
    v_lshlrev_b32 v240, 16, v210
    v_mfma_f32_16x16x32_bf16 v[200:203], a[248:251], v[144:147], v[200:203]
    v_and_b32 v241, 0xffff0000, v210
    v_fmac_f32_e64 v236, s76, v240
    v_mfma_f32_16x16x32_bf16 v[204:207], a[224:227], v[172:175], v[204:207]
    v_fmac_f32 v237, s76, v241
    v_lshlrev_b32 v240, 16, v211
    v_mfma_f32_16x16x32_bf16 v[204:207], a[228:231], v[168:171], v[204:207]
    v_and_b32 v241, 0xffff0000, v211
    v_fmac_f32_e64 v238, s76, v240
    v_mfma_f32_16x16x32_bf16 v[204:207], a[232:235], v[164:167], v[204:207]
    v_fmac_f32_e64 v239, s76, v241
    v_mfma_f32_16x16x32_bf16 v[204:207], a[236:239], v[160:163], v[204:207]
    v_mov_b32_e64 v24, 0
    buffer_atomic_add v24, v43, s[12:15], s40 offen sc0
    ds_write_b128 v38, v[200:203] offset:8192
    v_mfma_f32_16x16x32_bf16 v[204:207], a[240:243], v[156:159], v[204:207]
    v_mfma_f32_16x16x32_bf16 v[204:207], a[244:247], v[152:155], v[204:207]
    s_waitcnt vmcnt(9)
    v_cmp_ne_u32 vcc, s46, v7
    s_and_b64 vcc, vcc, 3
    s_cbranch_scc0 L_pdone_4
    s_waitcnt vmcnt(4)
    v_cmp_ne_u32 vcc, s46, v23
    s_and_b64 vcc, vcc, 3
    s_cbranch_scc0 L_pdone_4
    s_waitcnt vmcnt(0)
    v_cmp_ne_u32 vcc, s46, v24
    s_and_b64 vcc, vcc, 3
    s_cbranch_scc1 L_slow_3
L_pdone_4:
    s_and_b32 m0, s90, 0x7fffffff
    s_mov_b32 s79, 0
    buffer_load_dwordx4 v17, s[12:15], s79 offen sc1 lds
    v_mfma_f32_16x16x32_bf16 v[204:207], a[248:251], v[148:151], v[204:207]
    v_mfma_f32_16x16x32_bf16 v[204:207], a[252:255], v[144:147], v[204:207]
    v_mfma_f32_16x16x32_bf16 v[180:183], v[176:179], a[0:3], 0
    buffer_load_dwordx4 v18, s[12:15], s79 offen offset:1024 sc1 lds
    v_mfma_f32_16x16x32_bf16 v[184:187], v[176:179], a[4:7], 0
    v_mfma_f32_16x16x32_bf16 v[180:183], v[176:179], a[8:11], v[180:183]
    v_mfma_f32_16x16x32_bf16 v[184:187], v[176:179], a[12:15], v[184:187]
    buffer_load_dwordx4 v19, s[12:15], s79 offen offset:2048 sc1 lds
    s_nop 1
    ds_write_b128 v38, v[204:207] offset:12288
    v_mfma_f32_16x16x32_bf16 v[180:183], v[176:179], a[16:19], v[180:183]
    v_mfma_f32_16x16x32_bf16 v[184:187], v[176:179], a[20:23], v[184:187]
    v_mfma_f32_16x16x32_bf16 v[180:183], v[176:179], a[24:27], v[180:183]
    buffer_load_dwordx4 v20, s[12:15], s79 offen offset:3072 sc1 lds
    s_waitcnt lgkmcnt(0)
    s_barrier
    v_mfma_f32_16x16x32_bf16 v[184:187], v[176:179], a[28:31], v[184:187]
    ds_read_b128 v[216:219], v39 offset:0
    ds_read_b128 v[220:223], v39 offset:1024
    ds_read_b128 v[224:227], v39 offset:2048
    ds_read_b128 v[228:231], v39 offset:3072
    v_mfma_f32_16x16x32_bf16 v[180:183], v[176:179], a[32:35], v[180:183]
    v_mfma_f32_16x16x32_bf16 v[184:187], v[176:179], a[36:39], v[184:187]
    s_add_u32 m0, s90, 4096
    s_mov_b32 s79, 139264
    buffer_load_dwordx4 v17, s[12:15], s79 offen sc1 lds
    v_mfma_f32_16x16x32_bf16 v[180:183], v[176:179], a[40:43], v[180:183]
    v_mfma_f32_16x16x32_bf16 v[184:187], v[176:179], a[44:47], v[184:187]
    v_mfma_f32_16x16x32_bf16 v[180:183], v[176:179], a[48:51], v[180:183]
    buffer_load_dwordx4 v18, s[12:15], s79 offen offset:1024 sc1 lds
    v_mfma_f32_16x16x32_bf16 v[184:187], v[176:179], a[52:55], v[184:187]
    v_mfma_f32_16x16x32_bf16 v[180:183], v[176:179], a[56:59], v[180:183]
    v_mfma_f32_16x16x32_bf16 v[184:187], v[176:179], a[60:63], v[184:187]
    buffer_load_dwordx4 v19, s[12:15], s79 offen offset:2048 sc1 lds
    s_waitcnt lgkmcnt(3)
    v_pk_add_f32 v[232:233], v[232:233], v[216:217]
    v_pk_add_f32 v[234:235], v[234:235], v[218:219]
    s_waitcnt lgkmcnt(2)
    v_pk_add_f32 v[232:233], v[232:233], v[220:221]
    v_pk_add_f32 v[234:235], v[234:235], v[222:223]
    s_waitcnt lgkmcnt(1)
    v_pk_add_f32 v[236:237], v[236:237], v[224:225]
    v_pk_add_f32 v[238:239], v[238:239], v[226:227]
    s_waitcnt lgkmcnt(0)
    v_pk_add_f32 v[236:237], v[236:237], v[228:229]
    v_pk_add_f32 v[238:239], v[238:239], v[230:231]
    v_cvt_pk_bf16_f32 v248, v232, v236
    v_cvt_pk_bf16_f32 v249, v233, v237
    v_cvt_pk_bf16_f32 v250, v234, v238
    v_cvt_pk_bf16_f32 v251, v235, v239
    buffer_store_dwordx4 v[248:251], v38, s[12:15], s43 offen sc1
    v_mfma_f32_16x16x32_bf16 v[180:183], v[176:179], a[64:67], v[180:183]
    ds_read_b64_tr_b16 a[128:129], v13 offset:0
    s_add_u32 m0, s90, 28672
    s_mov_b32 s79, 128
    buffer_load_dwordx4 v17, s[12:15], s79 offen sc1 lds
    v_mfma_f32_16x16x32_bf16 v[184:187], v[176:179], a[68:71], v[184:187]
    v_mov_b32_e64 v25, 0
    buffer_atomic_add v25, v252, s[12:15], s41 offen sc0
    ds_read_b64_tr_b16 a[130:131], v13 offset:256
    ds_read_b64_tr_b16 a[136:137], v13 offset:1024
    v_mfma_f32_16x16x32_bf16 v[180:183], v[176:179], a[72:75], v[180:183]
    ds_read_b64_tr_b16 a[138:139], v13 offset:1280
    ds_read_b64_tr_b16 a[144:145], v13 offset:2048
    buffer_load_dwordx4 v18, s[12:15], s79 offen offset:1024 sc1 lds
    v_mfma_f32_16x16x32_bf16 v[184:187], v[176:179], a[76:79], v[184:187]
    ds_read_b64_tr_b16 a[146:147], v13 offset:2304
    ds_read_b64_tr_b16 a[152:153], v13 offset:3072
    v_mfma_f32_16x16x32_bf16 v[180:183], v[176:179], a[80:83], v[180:183]
    ds_read_b64_tr_b16 a[154:155], v13 offset:3328
    buffer_load_dwordx4 v19, s[12:15], s79 offen offset:2048 sc1 lds
    v_mfma_f32_16x16x32_bf16 v[184:187], v[176:179], a[84:87], v[184:187]
    ds_read_b64_tr_b16 a[132:133], v13 offset:4096
    ds_read_b64_tr_b16 a[134:135], v13 offset:4352
    v_mfma_f32_16x16x32_bf16 v[180:183], v[176:179], a[88:91], v[180:183]
    ds_read_b64_tr_b16 a[140:141], v13 offset:5120
    ds_read_b64_tr_b16 a[142:143], v13 offset:5376
    buffer_load_dwordx4 v20, s[12:15], s79 offen offset:3072 sc1 lds
    v_mfma_f32_16x16x32_bf16 v[184:187], v[176:179], a[92:95], v[184:187]
    ds_read_b64_tr_b16 a[148:149], v13 offset:6144
    ds_read_b64_tr_b16 a[150:151], v13 offset:6400
    v_mfma_f32_16x16x32_bf16 v[180:183], v[176:179], a[96:99], v[180:183]
    ds_read_b64_tr_b16 a[156:157], v13 offset:7168
    ds_read_b64_tr_b16 a[158:159], v13 offset:7424
    s_add_u32 m0, s90, 32768
    s_mov_b32 s79, 139392
    buffer_load_dwordx4 v17, s[12:15], s79 offen sc1 lds
    v_mfma_f32_16x16x32_bf16 v[184:187], v[176:179], a[100:103], v[184:187]
    s_waitcnt vmcnt(20)
    ds_read_b64_tr_b16 a[160:161], v13 offset:32768
    v_mfma_f32_16x16x32_bf16 v[180:183], v[176:179], a[104:107], v[180:183]
    ds_read_b64_tr_b16 a[162:163], v13 offset:33024
    ds_read_b64_tr_b16 a[168:169], v13 offset:33792
    buffer_load_dwordx4 v18, s[12:15], s79 offen offset:1024 sc1 lds
    v_mfma_f32_16x16x32_bf16 v[184:187], v[176:179], a[108:111], v[184:187]
    ds_read_b64_tr_b16 a[170:171], v13 offset:34048
    ds_read_b64_tr_b16 a[176:177], v13 offset:34816
    v_mfma_f32_16x16x32_bf16 v[180:183], v[176:179], a[112:115], v[180:183]
    ds_read_b64_tr_b16 a[178:179], v13 offset:35072
    ds_read_b64_tr_b16 a[184:185], v13 offset:35840
    buffer_load_dwordx4 v19, s[12:15], s79 offen offset:2048 sc1 lds
    v_mfma_f32_16x16x32_bf16 v[184:187], v[176:179], a[116:119], v[184:187]
    ds_read_b64_tr_b16 a[186:187], v13 offset:36096
    s_waitcnt vmcnt(17)
    v_mfma_f32_16x16x32_bf16 v[180:183], v[176:179], a[120:123], v[180:183]
    ds_read_b64_tr_b16 a[164:165], v13 offset:36864
    ds_read_b64_tr_b16 a[166:167], v13 offset:37120
    v_mfma_f32_16x16x32_bf16 v[184:187], v[176:179], a[124:127], v[184:187]
    ds_read_b64_tr_b16 a[172:173], v13 offset:37888
    ds_read_b64_tr_b16 a[174:175], v13 offset:38144
    s_waitcnt lgkmcnt(14)
    v_mfma_f32_16x16x32_bf16 v[180:183], v[176:179], a[128:131], v[180:183]
    ds_read_b64_tr_b16 a[180:181], v13 offset:38912
    ds_read_b64_tr_b16 a[182:183], v13 offset:39168
    v_mfma_f32_16x16x32_bf16 v[184:187], v[176:179], a[132:135], v[184:187]
    ds_read_b64_tr_b16 a[188:189], v13 offset:39936
    ds_read_b64_tr_b16 a[190:191], v13 offset:40192
    s_add_u32 s40, s40, 0x8000
    v_and_b32 v4, 31, v1
    v_lshrrev_b32_e64 v5, 5, v1
    v_mul_u32_u24 v5, 576, v5
    v_lshlrev_b32 v6, 2, v4
    v_xor_b32 v21, v5, v6
    v_xor_b32 v26, 0xa0, v21
    v_mov_b32_e64 v161, 0
    v_accvgpr_write_b32 a225, 0
    v_accvgpr_write_b32 a229, 0
    v_mov_b32_e64 v162, 0
    v_accvgpr_write_b32 a226, 0
    v_accvgpr_write_b32 a230, 0
    v_mov_b32_e64 v163, 0
    v_accvgpr_write_b32 a227, 0
    v_accvgpr_write_b32 a231, 0
    s_mov_b64 exec, 0
    s_cmp_eq_u32 s4, 0
    s_cbranch_scc1 L_walk0
    s_cmp_eq_u32 s4, 1
    s_cbranch_scc1 L_walk1
    s_cmp_eq_u32 s4, 2
    s_cbranch_scc1 L_walk2
    s_branch L_walk3
L_walk_back:
    s_mov_b64 exec, -1
    s_waitcnt vmcnt(9)
    s_waitcnt lgkmcnt(0)
    s_barrier
    ds_read2st64_b32 v[128:129], v21 offset0:0 offset1:1
    ds_read2st64_b32 v[130:131], v26 offset0:0 offset1:1
    ds_read2st64_b32 v[132:133], v21 offset0:4 offset1:5
    ds_read2st64_b32 v[134:135], v26 offset0:4 offset1:5
    ds_read2st64_b32 v[136:137], v21 offset0:8 offset1:9
    ds_read2st64_b32 v[138:139], v26 offset0:8 offset1:9
    v_mfma_f32_16x16x32_bf16 v[180:183], v[176:179], a[136:139], v[180:183]
    ds_read2st64_b32 v[140:141], v21 offset0:12 offset1:13
    v_mfma_f32_16x16x32_bf16 v[184:187], v[176:179], a[140:143], v[184:187]
    ds_read2st64_b32 v[142:143], v26 offset0:12 offset1:13
    s_add_u32 m0, s78, 32768
    s_mov_b32 s79, 1376256
    buffer_load_dwordx4 v9, s[16:19], s79 offen lds
    v_mfma_f32_16x16x32_bf16 v[180:183], v[176:179], a[144:147], v[180:183]
    ds_read2st64_b32 v[144:145], v21 offset0:16 offset1:17
    v_mfma_f32_16x16x32_bf16 v[184:187], v[176:179], a[148:151], v[184:187]
    ds_read2st64_b32 v[146:147], v26 offset0:16 offset1:17
    v_mfma_f32_16x16x32_bf16 v[180:183], v[176:179], a[152:155], v[180:183]
    ds_read2st64_b32 v[148:149], v21 offset0:20 offset1:21
    buffer_load_dwordx4 v10, s[16:19], s79 offen offset:1024 lds
    v_mfma_f32_16x16x32_bf16 v[184:187], v[176:179], a[156:159], v[184:187]
    ds_read2st64_b32 v[150:151], v26 offset0:20 offset1:21
    v_mfma_f32_16x16x32_bf16 v[180:183], v[176:179], a[160:163], v[180:183]
    ds_read2st64_b32 v[152:153], v21 offset0:24 offset1:25
    v_mfma_f32_16x16x32_bf16 v[184:187], v[176:179], a[164:167], v[184:187]
    ds_read2st64_b32 v[154:155], v26 offset0:24 offset1:25
    buffer_load_dwordx4 v11, s[16:19], s79 offen offset:2048 lds
    v_mfma_f32_16x16x32_bf16 v[180:183], v[176:179], a[168:171], v[180:183]
    v_mfma_f32_16x16x32_bf16 v[184:187], v[176:179], a[172:175], v[184:187]
    v_mfma_f32_16x16x32_bf16 v[180:183], v[176:179], a[176:179], v[180:183]
    v_mfma_f32_16x16x32_bf16 v[184:187], v[176:179], a[180:183], v[184:187]
    v_mfma_f32_16x16x32_bf16 v[180:183], v[176:179], a[184:187], v[180:183]
    v_mfma_f32_16x16x32_bf16 v[184:187], v[176:179], a[188:191], v[184:187]
    s_waitcnt lgkmcnt(12)
    v_mfma_f32_32x32x16_bf16 v[64:79], a[0:3], v[128:131], 0
    ds_read2st64_b32 v[156:157], v21 offset0:28 offset1:29
    buffer_load_dwordx4 v12, s[16:19], s79 offen offset:3072 lds
    s_lshl_b32 s5, s66, 10
    s_mul_i32 s6, s69, 20480
    v_mfma_f32_32x32x16_bf16 v[80:95], a[4:7], v[128:131], 0
    ds_read2st64_b32 v[158:159], v26 offset0:28 offset1:29
    s_add_u32 m0, s78, 36864
    s_nop 0
    buffer_load_dwordx4 v9, s[20:23], s79 offen lds
    s_add_u32 s5, s5, s6
    s_waitcnt lgkmcnt(12)
    v_mfma_f32_32x32x16_bf16 v[64:79], a[8:11], v[132:135], v[64:79]
    ds_read2st64_b32 v[128:129], v21 offset0:32 offset1:33
    s_waitcnt vmcnt(13)
    buffer_atomic_add v2, v40, s[12:15], s84 offen
    s_add_u32 s5, s5, 360448
    v_mfma_f32_32x32x16_bf16 v[80:95], a[12:15], v[132:135], v[80:95]
    ds_read2st64_b32 v[130:131], v26 offset0:32 offset1:33
    buffer_load_dwordx4 v10, s[20:23], s79 offen offset:1024 lds
    v_lshl_add_u32 v22, v4, 3, s5
    s_mov_b32 s93, 0x03020302
    s_waitcnt lgkmcnt(12)
    v_mfma_f32_32x32x16_bf16 v[64:79], a[16:19], v[136:139], v[64:79]
    ds_read2st64_b32 v[132:133], v21 offset0:36 offset1:37
    buffer_load_dwordx4 v11, s[20:23], s79 offen offset:2048 lds
    v_lshrrev_b32 v5, 4, v1
    v_and_b32_e64 v6, 15, v1
    v_mfma_f32_32x32x16_bf16 v[80:95], a[20:23], v[136:139], v[80:95]
    ds_read2st64_b32 v[134:135], v26 offset0:36 offset1:37
    s_waitcnt lgkmcnt(8)
    v_and_b32 v4, 1, v5
    v_mul_u32_u24 v4, 57344, v4
    v_lshl_add_u32 v4, v6, 4, v4
    v_lshrrev_b32_e64 v7, 1, v5
    v_mfma_f32_32x32x16_bf16 v[64:79], a[24:27], v[140:143], v[64:79]
    ds_read2st64_b32 v[136:137], v21 offset0:40 offset1:41
    buffer_load_dwordx4 v12, s[20:23], s79 offen offset:3072 lds
    v_lshl_add_u32 v4, v7, 8, v4
    s_mul_i32 s5, s66, 458752
    v_mfma_f32_32x32x16_bf16 v[80:95], a[28:31], v[140:143], v[80:95]
    ds_read2st64_b32 v[138:139], v26 offset0:40 offset1:41
    s_waitcnt vmcnt(15)
    v_cmp_eq_u32 vcc, s46, v25
    s_cbranch_vccz L_slow_5x
L_pdone_6:
    s_lshl_b32 s6, s67, 2
    s_add_u32 s6, s6, s4
    s_lshl_b32 s7, s6, 10
    v_mfma_f32_32x32x16_bf16 v[64:79], a[32:35], v[144:147], v[64:79]
    ds_read2st64_b32 v[140:141], v21 offset0:44 offset1:45
    s_add_u32 s5, s5, 6471680
    s_add_u32 s7, s7, s5
    v_add_u32 v24, s7, v4
    s_mul_i32 s7, s68, 57344
    s_add_u32 s5, s5, s7
    v_mfma_f32_32x32x16_bf16 v[80:95], a[36:39], v[144:147], v[80:95]
    ds_read2st64_b32 v[142:143], v26 offset0:44 offset1:45
    s_lshl1_add_u32 s5, s90, s5
    v_add_u32_e64 v44, s5, v3
    s_lshl_b32 s5, s66, 13
    s_add_u32 s5, s5, 589824
    s_mul_i32 s6, s6, 37
    v_mfma_f32_32x32x16_bf16 v[64:79], a[40:43], v[148:151], v[64:79]
    ds_read2st64_b32 v[144:145], v21 offset0:48 offset1:49
    s_and_b32 s6, s6, 0x600
    s_add_u32 s82, s5, s6
    s_lshl1_add_u32 s6, s4, s68
    s_lshl_b32 s6, s6, 8
    s_add_u32 s42, s5, s6
    v_mfma_f32_32x32x16_bf16 v[80:95], a[44:47], v[148:151], v[80:95]
    ds_read2st64_b32 v[146:147], v26 offset0:48 offset1:49
    s_waitcnt lgkmcnt(8)
    s_movk_i32 s37, 4096
    s_movk_i32 s38, 8192
    s_movk_i32 s39, 12288
    s_add_u32 s88, s78, 32768
    v_mfma_f32_32x32x16_bf16 v[64:79], a[48:51], v[152:155], v[64:79]
    ds_read2st64_b32 v[148:149], v21 offset0:52 offset1:53
    s_lshl_b32 s89, s4, 14
    v_add_u32 v28, s88, v3
    v_add_u32 v29, s89, v3
    v_lshrrev_b32 v4, 4, v0
    v_and_b32_e64 v5, 15, v0
    v_mfma_f32_32x32x16_bf16 v[80:95], a[52:55], v[152:155], v[80:95]
    ds_read2st64_b32 v[150:151], v26 offset0:52 offset1:53
    v_lshrrev_b32_e64 v6, 1, v5
    v_and_b32 v7, 1, v5
    v_lshl_add_u32 v6, v6, 2, v7
    s_lshl_b32 s5, s69, 12
    v_lshl_add_u32 v6, v6, 7, s5
    v_mfma_f32_32x32x16_bf16 v[64:79], a[56:59], v[156:159], v[64:79]
    ds_read2st64_b32 v[152:153], v21 offset0:56 offset1:57
    s_add_u32 s79, s45, 0
    buffer_load_dwordx4 v[188:191], v3, s[12:15], s79 offen sc1
    s_lshl_b32 s6, s68, 6
    v_mfma_f32_32x32x16_bf16 v[80:95], a[60:63], v[156:159], v[80:95]
    ds_read2st64_b32 v[154:155], v26 offset0:56 offset1:57
    v_lshl_add_u32 v7, v4, 2, s6
    v_add_u32 v6, v6, v7
    v_and_b32 v7, 3, v5
    v_lshlrev_b32 v7, 5, v7
    v_xor_b32 v27, v6, v7
    v_mfma_f32_32x32x16_bf16 v[64:79], a[64:67], v[128:131], v[64:79]
    ds_read2st64_b32 v[156:157], v21 offset0:60 offset1:61
    buffer_load_dwordx4 v[192:195], v3, s[12:15], s79 offen offset:1024 sc1
    v_lshrrev_b32 v6, 2, v4
    v_and_b32 v7, 3, v4
    v_mfma_f32_32x32x16_bf16 v[80:95], a[68:71], v[128:131], v[80:95]
    ds_read2st64_b32 v[158:159], v26 offset0:60 offset1:61
    s_waitcnt lgkmcnt(8)
    v_lshl_add_u32 v6, v6, 4, v7
    v_mul_u32_u24 v6, 896, v6
    v_lshl_add_u32 v6, v5, 3, v6
    s_lshr_b32 s5, s66, 2
    v_mfma_f32_32x32x16_bf16 v[64:79], a[72:75], v[132:135], v[64:79]
    ds_read2st64_b32 v[128:129], v21 offset0:64 offset1:65
    buffer_load_dwordx4 v[196:199], v3, s[12:15], s79 offen offset:2048 sc1
    s_lshl_b32 s5, s5, 8
    s_add_u32 s5, s5, s6
    v_mfma_f32_32x32x16_bf16 v[80:95], a[76:79], v[132:135], v[80:95]
    ds_read2st64_b32 v[130:131], v26 offset0:64 offset1:65
    s_and_b32 s6, s66, 3
    s_lshl_b32 s6, s6, 2
    s_add_u32 s5, s5, s6
    s_mul_i32 s5, s5, 896
    s_lshl_b32 s6, s69, 7
    v_mfma_f32_32x32x16_bf16 v[64:79], a[80:83], v[136:139], v[64:79]
    ds_read2st64_b32 v[132:133], v21 offset0:68 offset1:69
    buffer_load_dwordx4 v[200:203], v3, s[12:15], s79 offen offset:3072 sc1
    s_add_u32 s5, s5, s6
    v_add_u32 v45, s5, v6
    v_mfma_f32_32x32x16_bf16 v[80:95], a[84:87], v[136:139], v[80:95]
    ds_read2st64_b32 v[134:135], v26 offset0:68 offset1:69
    v_mul_u32_u24 v6, 288, v5
    v_lshl_add_u32 v6, v4, 4, v6
    v_add_u32 v41, 65536, v6
    v_lshrrev_b32_e64 v4, 4, v1
    v_mul_u32_u24 v6, 288, v4
    v_mfma_f32_32x32x16_bf16 v[64:79], a[88:91], v[140:143], v[64:79]
    ds_read2st64_b32 v[136:137], v21 offset0:72 offset1:73
    s_add_u32 s79, s45, 4096
    buffer_load_dwordx4 v[204:207], v3, s[12:15], s79 offen sc1
    v_lshl_add_u32 v6, v5, 4, v6
    v_mfma_f32_32x32x16_bf16 v[80:95], a[92:95], v[140:143], v[80:95]
    ds_read2st64_b32 v[138:139], v26 offset0:72 offset1:73
    s_waitcnt lgkmcnt(8)
    s_mul_i32 s5, s4, 4608
    s_add_u32 s5, s5, 65536
    v_add_u32 v42, s5, v6
    v_and_b32_e64 v4, 62, v1
    v_mfma_f32_32x32x16_bf16 v[64:79], a[96:99], v[144:147], v[64:79]
    ds_read2st64_b32 v[140:141], v21 offset0:76 offset1:77
    buffer_load_dwordx4 v[208:211], v3, s[12:15], s79 offen offset:1024 sc1
    v_lshlrev_b32_e64 v4, 25, v4
    v_lshl_add_u32 v8, v1, 8, v4
    v_mfma_f32_32x32x16_bf16 v[80:95], a[100:103], v[144:147], v[80:95]
    ds_read2st64_b32 v[142:143], v26 offset0:76 offset1:77
    v_mfma_f32_32x32x16_bf16 v[64:79], a[104:107], v[148:151], v[64:79]
    ds_read2st64_b32 v[144:145], v21 offset0:80 offset1:81
    buffer_load_dwordx4 v[212:215], v3, s[12:15], s79 offen offset:2048 sc1
    v_mov_b32_e64 v23, 0
    buffer_atomic_add v23, v43, s[12:15], s40 offen sc0
    v_mfma_f32_32x32x16_bf16 v[80:95], a[108:111], v[148:151], v[80:95]
    ds_read2st64_b32 v[146:147], v26 offset0:80 offset1:81
    s_waitcnt vmcnt(17)
    s_barrier
    v_mfma_f32_32x32x16_bf16 v[64:79], a[112:115], v[152:155], v[64:79]
    ds_read2st64_b32 v[148:149], v21 offset0:84 offset1:85
    v_mfma_f32_32x32x16_bf16 v[80:95], a[116:119], v[152:155], v[80:95]
    ds_read2st64_b32 v[150:151], v26 offset0:84 offset1:85
    s_waitcnt lgkmcnt(8)
    buffer_load_dwordx4 v[216:219], v3, s[12:15], s79 offen offset:3072 sc1
    v_mfma_f32_32x32x16_bf16 v[64:79], a[120:123], v[156:159], v[64:79]
    ds_read2st64_b32 v[152:153], v21 offset0:88 offset1:89
    s_waitcnt vmcnt(9)
    ds_read_b64_tr_b16 a[192:193], v13 offset:32768
    ds_read_b64_tr_b16 a[194:195], v13 offset:33024
    v_mfma_f32_32x32x16_bf16 v[80:95], a[124:127], v[156:159], v[80:95]
    ds_read2st64_b32 v[154:155], v26 offset0:88 offset1:89
    s_add_u32 s79, s45, 8192
    buffer_load_dwordx4 v[220:223], v3, s[12:15], s79 offen sc1
    ds_read_b64_tr_b16 a[200:201], v13 offset:33792
    ds_read_b64_tr_b16 a[202:203], v13 offset:34048
    v_mfma_f32_32x32x16_bf16 v[64:79], a[128:131], v[128:131], v[64:79]
    ds_read2st64_b32 v[156:157], v21 offset0:92 offset1:93
    ds_read_b64_tr_b16 a[208:209], v13 offset:34816
    ds_read_b64_tr_b16 a[210:211], v13 offset:35072
    buffer_load_dwordx2 v[60:61], v22, s[12:15], 0 offen offset:0 sc1
    v_mfma_f32_32x32x16_bf16 v[80:95], a[132:135], v[128:131], v[80:95]
    ds_read2st64_b32 v[158:159], v26 offset0:92 offset1:93
    buffer_load_dwordx4 v[224:227], v3, s[12:15], s79 offen offset:1024 sc1
    ds_read_b64_tr_b16 a[216:217], v13 offset:35840
    ds_read_b64_tr_b16 a[218:219], v13 offset:36096
    v_mfma_f32_32x32x16_bf16 v[64:79], a[136:139], v[132:135], v[64:79]
    ds_read2st64_b32 v[128:129], v21 offset0:96 offset1:97
    ds_read_b64_tr_b16 a[196:197], v13 offset:36864
    ds_read_b64_tr_b16 a[198:199], v13 offset:37120
    v_mfma_f32_32x32x16_bf16 v[80:95], a[140:143], v[132:135], v[80:95]
    ds_read2st64_b32 v[130:131], v26 offset0:96 offset1:97
    s_waitcnt lgkmcnt(14)
    buffer_load_dwordx4 v[228:231], v3, s[12:15], s79 offen offset:2048 sc1
    ds_read_b64_tr_b16 a[204:205], v13 offset:37888
    ds_read_b64_tr_b16 a[206:207], v13 offset:38144
    v_mfma_f32_32x32x16_bf16 v[64:79], a[144:147], v[136:139], v[64:79]
    ds_read2st64_b32 v[132:133], v21 offset0:100 offset1:101
    ds_read_b64_tr_b16 a[212:213], v13 offset:38912
    ds_read_b64_tr_b16 a[214:215], v13 offset:39168
    v_mfma_f32_32x32x16_bf16 v[80:95], a[148:151], v[136:139], v[80:95]
    ds_read2st64_b32 v[134:135], v26 offset0:100 offset1:101
    buffer_load_dwordx4 v[232:235], v3, s[12:15], s79 offen offset:3072 sc1
    ds_read_b64_tr_b16 a[220:221], v13 offset:39936
    ds_read_b64_tr_b16 a[222:223], v13 offset:40192
    v_mfma_f32_32x32x16_bf16 v[64:79], a[152:155], v[140:143], v[64:79]
    ds_read2st64_b32 v[136:137], v21 offset0:104 offset1:105
    v_mfma_f32_32x32x16_bf16 v[80:95], a[156:159], v[140:143], v[80:95]
    ds_read2st64_b32 v[138:139], v26 offset0:104 offset1:105
    s_add_u32 s79, s45, 12288
    buffer_load_dwordx4 v[236:239], v3, s[12:15], s79 offen sc1
    v_mfma_f32_32x32x16_bf16 v[64:79], a[160:163], v[144:147], v[64:79]
    ds_read2st64_b32 v[140:141], v21 offset0:108 offset1:109
    v_mov_b32 v25, 0
    buffer_atomic_add v25, v43, s[12:15], s40 offen sc0
    v_mfma_f32_32x32x16_bf16 v[80:95], a[164:167], v[144:147], v[80:95]
    ds_read2st64_b32 v[142:143], v26 offset0:108 offset1:109
    s_waitcnt lgkmcnt(14)
    buffer_load_dwordx4 v[240:243], v3, s[12:15], s79 offen offset:1024 sc1
    s_waitcnt lgkmcnt(4)
    v_mfma_f32_16x16x32_bf16 v[180:183], v[176:179], a[192:195], v[180:183]
    v_mfma_f32_16x16x32_bf16 v[184:187], v[176:179], a[196:199], v[184:187]
    v_mfma_f32_16x16x32_bf16 v[180:183], v[176:179], a[200:203], v[180:183]
    v_mfma_f32_16x16x32_bf16 v[184:187], v[176:179], a[204:207], v[184:187]
    v_mfma_f32_16x16x32_bf16 v[180:183], v[176:179], a[208:211], v[180:183]
    v_mfma_f32_16x16x32_bf16 v[184:187], v[176:179], a[212:215], v[184:187]
    v_mfma_f32_16x16x32_bf16 v[180:183], v[176:179], a[216:219], v[180:183]
    v_mfma_f32_16x16x32_bf16 v[184:187], v[176:179], a[220:223], v[184:187]
    v_mfma_f32_32x32x16_bf16 v[64:79], a[168:171], v[148:151], v[64:79]
    ds_read2st64_b32 v[144:145], v21 offset0:128 offset1:129
    v_mfma_f32_32x32x16_bf16 v[80:95], a[172:175], v[148:151], v[80:95]
    ds_read2st64_b32 v[146:147], v26 offset0:128 offset1:129
    ds_read2st64_b32 v[148:149], v21 offset0:132 offset1:133
    v_mfma_f32_32x32x16_bf16 v[64:79], a[176:179], v[152:155], v[64:79]
    buffer_load_dwordx4 v[244:247], v3, s[12:15], s79 offen offset:2048 sc1
    ds_read2st64_b32 v[150:151], v26 offset0:132 offset1:133
    v_cvt_pk_bf16_f32 v54, v180, v180
    v_and_b32 v54, 0xffff0000, v54
    v_sub_f32_e64 v55, v180, v54
    v_mfma_f32_32x32x16_bf16 v[80:95], a[180:183], v[152:155], v[80:95]
    ds_read2st64_b32 v[152:153], v21 offset0:136 offset1:137
    v_cvt_pk_bf16_f32 v54, v54, v55
    v_accvgpr_write_b32 a224, v54
    v_cvt_pk_bf16_f32 v54, v184, v184
    v_and_b32 v54, 0xffff0000, v54
    v_sub_f32 v55, v184, v54
    v_cvt_pk_bf16_f32 v54, v54, v55
    v_mfma_f32_32x32x16_bf16 v[64:79], a[184:187], v[156:159], v[64:79]
    buffer_load_dwordx4 v[248:251], v3, s[12:15], s79 offen offset:3072 sc1
    ds_read2st64_b32 v[154:155], v26 offset0:136 offset1:137
    v_accvgpr_write_b32 a228, v54
    v_mfma_f32_32x32x16_bf16 v[80:95], a[188:191], v[156:159], v[80:95]
    s_waitcnt lgkmcnt(8)
    v_mfma_f32_32x32x16_bf16 v[64:79], a[192:195], v[128:131], v[64:79]
    s_add_u32 s79, s45, 40960
    buffer_load_dwordx4 a[240:243], v3, s[12:15], s79 offen sc1
    v_mfma_f32_32x32x16_bf16 v[80:95], a[196:199], v[128:131], v[80:95]
    ds_read2st64_b32 v[128:129], v21 offset0:112 offset1:113
    v_mfma_f32_32x32x16_bf16 v[64:79], a[200:203], v[132:135], v[64:79]
    buffer_load_dwordx4 a[244:247], v3, s[12:15], s79 offen offset:1024 sc1
    ds_read2st64_b32 v[130:131], v26 offset0:112 offset1:113
    v_mfma_f32_32x32x16_bf16 v[80:95], a[204:207], v[132:135], v[80:95]
    ds_read2st64_b32 v[132:133], v21 offset0:116 offset1:117
    v_mfma_f32_32x32x16_bf16 v[64:79], a[208:211], v[136:139], v[64:79]
    buffer_load_dwordx4 a[248:251], v3, s[12:15], s79 offen offset:2048 sc1
    ds_read2st64_b32 v[134:135], v26 offset0:116 offset1:117
    v_mfma_f32_32x32x16_bf16 v[80:95], a[212:215], v[136:139], v[80:95]
    s_waitcnt lgkmcnt(10)
    s_waitcnt vmcnt(11)
    v_cmp_ne_u32 vcc, s32, v61
    s_cbranch_vccnz L_sslow_7
L_sdone_8:
    ds_read2st64_b32 v[136:137], v21 offset0:120 offset1:121
    v_perm_b32 v160, v60, v60, s93
    v_cvt_f32_f16 v60, v60
    v_mul_f32 v61, v60, v60
    v_mfma_f32_32x32x16_bf16 v[64:79], a[216:219], v[140:143], v[64:79]
    buffer_load_dwordx4 a[252:255], v3, s[12:15], s79 offen offset:3072 sc1
    ds_read2st64_b32 v[138:139], v26 offset0:120 offset1:121
    v_mul_f32 v14, 0xc0135761, v60
    v_rcp_f32 v16, v61
    v_mul_f32 v15, v61, v14
    v_mul_f32 v15, 0x3d372713, v15
    v_mfma_f32_32x32x16_bf16 v[80:95], a[220:223], v[140:143], v[80:95]
    ds_read2st64_b32 v[140:141], v21 offset0:124 offset1:125
    v_mfma_f32_32x32x16_bf16 v[64:79], a[224:227], v[160:163], v[64:79]
    ds_read2st64_b32 v[142:143], v26 offset0:124 offset1:125
    v_mfma_f32_32x32x16_bf16 v[80:95], a[228:231], v[160:163], v[80:95]
    v_cmp_ne_u32 vcc, s46, v23
    s_and_b64 vcc, vcc, 3
    s_cbranch_scc1 L_slow_9x
L_pdone_10:
    s_waitcnt lgkmcnt(6)
    v_mfma_f32_32x32x16_bf16 v[96:111], a[0:3], v[128:131], 0
    ds_read2st64_b32 v[156:157], v21 offset0:140 offset1:141
L_pad3:
    s_cbranch_execz L_walk_back
    s_add_u32 m0, s90, 65536
    s_mov_b32 s79, 974848
    buffer_load_dwordx4 v17, s[12:15], s79 offen sc1 lds
    v_mfma_f32_32x32x16_bf16 v[112:127], a[4:7], v[128:131], 0
    ds_read2st64_b32 v[158:159], v26 offset0:140 offset1:141
    s_waitcnt lgkmcnt(6)
    v_mfma_f32_32x32x16_bf16 v[96:111], a[8:11], v[132:135], v[96:111]
    ds_read2st64_b32 v[128:129], v21 offset0:144 offset1:145
    buffer_load_dwordx4 v18, s[12:15], s79 offen offset:1024 sc1 lds
    v_mfma_f32_32x32x16_bf16 v[112:127], a[12:15], v[132:135], v[112:127]
    ds_read2st64_b32 v[130:131], v26 offset0:144 offset1:145
    v_mul_f32 v164, v64, v64
    v_mul_f32 v165, v65, v65
    v_mul_f32_e64 v166, v66, v66
    v_mul_f32 v167, v67, v67
    v_fma_f32 v164, v164, v15, v14
    s_waitcnt lgkmcnt(6)
    v_mfma_f32_32x32x16_bf16 v[96:111], a[16:19], v[136:139], v[96:111]
    ds_read2st64_b32 v[132:133], v21 offset0:148 offset1:149
    buffer_load_dwordx4 v19, s[12:15], s79 offen offset:2048 sc1 lds
    v_fma_f32 v165, v165, v15, v14
    v_fma_f32 v166, v166, v15, v14
    v_mfma_f32_32x32x16_bf16 v[112:127], a[20:23], v[136:139], v[112:127]
    ds_read2st64_b32 v[134:135], v26 offset0:148 offset1:149
    v_fma_f32 v167, v167, v15, v14
    v_mul_f32 v164, v164, v64
    v_mul_f32 v165, v165, v65
    v_mul_f32 v166, v166, v66
    s_waitcnt lgkmcnt(6)
    v_mfma_f32_32x32x16_bf16 v[96:111], a[24:27], v[140:143], v[96:111]
    ds_read2st64_b32 v[136:137], v21 offset0:152 offset1:153
    buffer_load_dwordx4 v20, s[12:15], s79 offen offset:3072 sc1 lds
    v_mul_f32_e64 v167, v167, v67
    v_mfma_f32_32x32x16_bf16 v[112:127], a[28:31], v[140:143], v[112:127]
    ds_read2st64_b32 v[138:139], v26 offset0:152 offset1:153
    v_exp_f32 v164, v164
    v_mul_f32 v168, v64, v80
    v_exp_f32_e64 v165, v165
    v_mfma_f32_32x32x16_bf16 v[96:111], a[32:35], v[144:147], v[96:111]
    ds_read2st64_b32 v[140:141], v21 offset0:156 offset1:157
    buffer_load_dwordx2 v[62:63], v22, s[12:15], 0 offen offset:256 sc1
    v_mul_f32_e64 v169, v65, v81
    v_mfma_f32_32x32x16_bf16 v[112:127], a[36:39], v[144:147], v[112:127]
    ds_read2st64_b32 v[142:143], v26 offset0:156 offset1:157
    v_exp_f32 v166, v166
    v_mul_f32 v170, v66, v82
    v_exp_f32_e64 v167, v167
    v_mfma_f32_32x32x16_bf16 v[96:111], a[40:43], v[148:151], v[96:111]
    ds_read2st64_b32 v[144:145], v21 offset0:160 offset1:161
    s_add_u32 m0, s90, 69632
    s_mov_b32 s79, 1114112
    buffer_load_dwordx4 v17, s[12:15], s79 offen sc1 lds
    v_mfma_f32_32x32x16_bf16 v[112:127], a[44:47], v[148:151], v[112:127]
    ds_read2st64_b32 v[146:147], v26 offset0:160 offset1:161
    s_waitcnt lgkmcnt(8)
    v_mul_f32 v171, v67, v83
    v_fma_f32 v164, v164, v16, v16
    v_fma_f32 v165, v165, v16, v16
    v_fma_f32 v166, v166, v16, v16
    v_mfma_f32_32x32x16_bf16 v[96:111], a[48:51], v[152:155], v[96:111]
    ds_read2st64_b32 v[148:149], v21 offset0:164 offset1:165
    buffer_load_dwordx4 v18, s[12:15], s79 offen offset:1024 sc1 lds
    v_fma_f32 v167, v167, v16, v16
    v_mfma_f32_32x32x16_bf16 v[112:127], a[52:55], v[152:155], v[112:127]
    ds_read2st64_b32 v[150:151], v26 offset0:164 offset1:165
    v_rcp_f32 v164, v164
    v_rcp_f32 v165, v165
    v_mfma_f32_32x32x16_bf16 v[96:111], a[56:59], v[156:159], v[96:111]
    ds_read2st64_b32 v[152:153], v21 offset0:168 offset1:169
    buffer_load_dwordx4 v19, s[12:15], s79 offen offset:2048 sc1 lds
    v_rcp_f32_e64 v166, v166
    v_mfma_f32_32x32x16_bf16 v[112:127], a[60:63], v[156:159], v[112:127]
    ds_read2st64_b32 v[154:155], v26 offset0:168 offset1:169
    v_rcp_f32 v167, v167
    v_mul_f32 v168, v168, v164
    v_mul_f32 v169, v169, v165
    v_mul_f32 v170, v170, v166
    v_mfma_f32_32x32x16_bf16 v[96:111], a[64:67], v[128:131], v[96:111]
    ds_read2st64_b32 v[156:157], v21 offset0:172 offset1:173
    s_add_u32 m0, s90, 94208
    s_mov_b32 s79, 974976
    buffer_load_dwordx4 v17, s[12:15], s79 offen sc1 lds
    v_mfma_f32_32x32x16_bf16 v[112:127], a[68:71], v[128:131], v[112:127]
    ds_read2st64_b32 v[158:159], v26 offset0:172 offset1:173
    s_waitcnt lgkmcnt(8)
    v_mul_f32 v171, v171, v167
    v_cvt_pk_bf16_f32 v172, v168, v169
    v_cvt_pk_bf16_f32 v173, v170, v171
    v_mul_f32_e64 v164, v68, v68
    v_mfma_f32_32x32x16_bf16 v[96:111], a[72:75], v[132:135], v[96:111]
    ds_read2st64_b32 v[128:129], v21 offset0:176 offset1:177
    buffer_load_dwordx4 v18, s[12:15], s79 offen offset:1024 sc1 lds
    v_mul_f32 v165, v69, v69
    v_mul_f32 v166, v70, v70
    v_mfma_f32_32x32x16_bf16 v[112:127], a[76:79], v[132:135], v[112:127]
    ds_read2st64_b32 v[130:131], v26 offset0:176 offset1:177
    v_mul_f32_e64 v167, v71, v71
    v_fma_f32 v164, v164, v15, v14
    v_fma_f32 v165, v165, v15, v14
    v_fma_f32 v166, v166, v15, v14
    v_fma_f32 v167, v167, v15, v14
    v_mfma_f32_32x32x16_bf16 v[96:111], a[80:83], v[136:139], v[96:111]
    ds_read2st64_b32 v[132:133], v21 offset0:180 offset1:181
    buffer_load_dwordx4 v19, s[12:15], s79 offen offset:2048 sc1 lds
    v_mul_f32 v164, v164, v68
    v_mul_f32 v165, v165, v69
    v_mfma_f32_32x32x16_bf16 v[112:127], a[84:87], v[136:139], v[112:127]
    ds_read2st64_b32 v[134:135], v26 offset0:180 offset1:181
    v_mul_f32 v166, v166, v70
    v_mul_f32 v167, v167, v71
    v_exp_f32 v164, v164
    v_mul_f32 v168, v68, v84
    v_mfma_f32_32x32x16_bf16 v[96:111], a[88:91], v[140:143], v[96:111]
    ds_read2st64_b32 v[136:137], v21 offset0:184 offset1:185
    buffer_load_dwordx4 v20, s[12:15], s79 offen offset:3072 sc1 lds
    v_exp_f32_e64 v165, v165
    v_mfma_f32_32x32x16_bf16 v[112:127], a[92:95], v[140:143], v[112:127]
    ds_read2st64_b32 v[138:139], v26 offset0:184 offset1:185
    s_waitcnt lgkmcnt(8)
    v_mul_f32 v169, v69, v85
    v_exp_f32 v166, v166
    v_mul_f32 v170, v70, v86
    v_mfma_f32_32x32x16_bf16 v[96:111], a[96:99], v[144:147], v[96:111]
    ds_read2st64_b32 v[140:141], v21 offset0:188 offset1:189
    s_add_u32 m0, s90, 98304
    s_mov_b32 s79, 1114240
    buffer_load_dwordx4 v17, s[12:15], s79 offen sc1 lds
    v_mfma_f32_32x32x16_bf16 v[112:127], a[100:103], v[144:147], v[112:127]
    ds_read2st64_b32 v[142:143], v26 offset0:188 offset1:189
    v_exp_f32 v167, v167
    v_mul_f32 v171, v71, v87
    v_fma_f32 v164, v164, v16, v16
    v_fma_f32 v165, v165, v16, v16
    v_mfma_f32_32x32x16_bf16 v[96:111], a[104:107], v[148:151], v[96:111]
    ds_read2st64_b32 v[144:145], v21 offset0:192 offset1:193
    buffer_load_dwordx4 v18, s[12:15], s79 offen offset:1024 sc1 lds
    v_fma_f32 v166, v166, v16, v16
    v_fma_f32 v167, v167, v16, v16
    v_mfma_f32_32x32x16_bf16 v[112:127], a[108:111], v[148:151], v[112:127]
    ds_read2st64_b32 v[146:147], v26 offset0:192 offset1:193
    v_rcp_f32 v164, v164
    v_rcp_f32 v165, v165
    v_mfma_f32_32x32x16_bf16 v[96:111], a[112:115], v[152:155], v[96:111]
    ds_read2st64_b32 v[148:149], v21 offset0:196 offset1:197
    buffer_load_dwordx4 v19, s[12:15], s79 offen offset:2048 sc1 lds
    v_rcp_f32_e64 v166, v166
    v_mfma_f32_32x32x16_bf16 v[112:127], a[116:119], v[152:155], v[112:127]
    ds_read2st64_b32 v[150:151], v26 offset0:196 offset1:197
    s_waitcnt lgkmcnt(8)
    v_rcp_f32 v167, v167
    v_mul_f32 v168, v168, v164
    v_mul_f32 v169, v169, v165
    v_mfma_f32_32x32x16_bf16 v[96:111], a[120:123], v[156:159], v[96:111]
    ds_read2st64_b32 v[152:153], v21 offset0:200 offset1:201
    v_mul_f32 v170, v170, v166
    v_mul_f32 v171, v171, v167
    v_cvt_pk_bf16_f32 v174, v168, v169
    v_cvt_pk_bf16_f32 v175, v170, v171
    v_mfma_f32_32x32x16_bf16 v[112:127], a[124:127], v[156:159], v[112:127]
    ds_read2st64_b32 v[154:155], v26 offset0:200 offset1:201
    s_and_b32 m0, s88, 0x7fffffff
    s_add_u32 s79, s45, 16384
    buffer_load_dwordx4 v3, s[12:15], s79 offen sc1 lds
    v_mfma_f32_32x32x16_bf16 v[96:111], a[128:131], v[128:131], v[96:111]
    ds_read2st64_b32 v[156:157], v21 offset0:204 offset1:205
    buffer_store_dwordx4 v[172:175], v24, s[12:15], 0 offen offset:0 sc1
    v_mfma_f32_32x32x16_bf16 v[112:127], a[132:135], v[128:131], v[112:127]
    ds_read2st64_b32 v[158:159], v26 offset0:204 offset1:205
    buffer_load_dwordx4 v3, s[12:15], s79 offen offset:1024 sc1 lds
    v_mul_f32 v164, v72, v72
    v_mul_f32 v165, v73, v73
    v_mfma_f32_32x32x16_bf16 v[96:111], a[136:139], v[132:135], v[96:111]
    ds_read2st64_b32 v[128:129], v21 offset0:208 offset1:209
    v_mul_f32 v166, v74, v74
    v_mul_f32 v167, v75, v75
    v_fma_f32 v164, v164, v15, v14
    v_fma_f32 v165, v165, v15, v14
    v_fma_f32 v166, v166, v15, v14
    v_mfma_f32_32x32x16_bf16 v[112:127], a[140:143], v[132:135], v[112:127]
    ds_read2st64_b32 v[130:131], v26 offset0:208 offset1:209
    s_waitcnt lgkmcnt(8)
    v_fma_f32 v167, v167, v15, v14
    v_mul_f32 v164, v164, v72
    v_mul_f32 v165, v165, v73
    v_mul_f32 v166, v166, v74
    v_mfma_f32_32x32x16_bf16 v[96:111], a[144:147], v[136:139], v[96:111]
    ds_read2st64_b32 v[132:133], v21 offset0:212 offset1:213
    buffer_load_dwordx4 v3, s[12:15], s79 offen offset:2048 sc1 lds
    v_mul_f32_e64 v167, v167, v75
    v_mfma_f32_32x32x16_bf16 v[112:127], a[148:151], v[136:139], v[112:127]
    ds_read2st64_b32 v[134:135], v26 offset0:212 offset1:213
    v_exp_f32 v164, v164
    v_mul_f32 v168, v72, v88
    v_exp_f32_e64 v165, v165
    v_mfma_f32_32x32x16_bf16 v[96:111], a[152:155], v[140:143], v[96:111]
    ds_read2st64_b32 v[136:137], v21 offset0:216 offset1:217
    buffer_load_dwordx4 v3, s[12:15], s79 offen offset:3072 sc1 lds
    ds_read2st64_b32 v[46:47], v27 offset0:0 offset1:1
    v_mul_f32_e64 v169, v73, v89
    v_mfma_f32_32x32x16_bf16 v[112:127], a[156:159], v[140:143], v[112:127]
    ds_read2st64_b32 v[138:139], v26 offset0:216 offset1:217
    ds_read2st64_b32 v[48:49], v27 offset0:112 offset1:113
    v_add_u32 v27, 65536, v27
    v_exp_f32 v166, v166
    v_mul_f32 v170, v74, v90
    v_mfma_f32_32x32x16_bf16 v[96:111], a[160:163], v[144:147], v[96:111]
    ds_read2st64_b32 v[140:141], v21 offset0:220 offset1:221
    s_waitcnt vmcnt(15)
    v_cmp_ne_u32 vcc, s32, v63
    s_cbranch_vccnz L_sslow_11
L_sdone_12:
    v_exp_f32 v167, v167
    v_mul_f32 v171, v75, v91
    v_mfma_f32_32x32x16_bf16 v[112:127], a[164:167], v[144:147], v[112:127]
    ds_read2st64_b32 v[142:143], v26 offset0:220 offset1:221
    s_waitcnt lgkmcnt(10)
    s_add_u32 m0, s88, 4096
    s_add_u32 s79, s45, 20480
    buffer_load_dwordx4 v3, s[12:15], s79 offen sc1 lds
    v_mfma_f32_32x32x16_bf16 v[96:111], a[168:171], v[148:151], v[96:111]
    v_perm_b32 v160, v62, v62, s93
    v_cvt_f32_f16 v62, v62
    v_mul_f32 v63, v62, v62
    v_mul_f32 v9, 0xc0135761, v62
    v_rcp_f32_e64 v11, v63
    v_mfma_f32_32x32x16_bf16 v[112:127], a[172:175], v[148:151], v[112:127]
    buffer_load_dwordx4 v3, s[12:15], s79 offen offset:1024 sc1 lds
    v_mul_f32_e64 v10, v63, v9
    v_mul_f32 v10, 0x3d372713, v10
    v_fma_f32 v164, v164, v16, v16
    v_mfma_f32_32x32x16_bf16 v[96:111], a[176:179], v[152:155], v[96:111]
    v_fma_f32 v165, v165, v16, v16
    v_fma_f32 v166, v166, v16, v16
    v_fma_f32 v167, v167, v16, v16
    v_rcp_f32 v164, v164
    v_mfma_f32_32x32x16_bf16 v[112:127], a[180:183], v[152:155], v[112:127]
    s_waitcnt vmcnt(14)
    s_waitcnt lgkmcnt(0)
    s_barrier
    v_add_u32 v21, 65536, v21
    v_add_u32 v26, 65536, v26
    v_mfma_f32_32x32x16_bf16 v[96:111], a[184:187], v[156:159], v[96:111]
    buffer_load_dwordx4 v3, s[12:15], s79 offen offset:2048 sc1 lds
    ds_read2st64_b32 v[144:145], v21 offset0:16 offset1:17
    ds_read2st64_b32 v[148:149], v21 offset0:20 offset1:21
    ds_read2st64_b32 v[152:153], v21 offset0:24 offset1:25
    v_mfma_f32_32x32x16_bf16 v[112:127], a[188:191], v[156:159], v[112:127]
    ds_read2st64_b32 v[146:147], v26 offset0:16 offset1:17
    ds_read2st64_b32 v[150:151], v26 offset0:20 offset1:21
    ds_read2st64_b32 v[154:155], v26 offset0:24 offset1:25
    v_rcp_f32_e64 v165, v165
    v_mfma_f32_32x32x16_bf16 v[96:111], a[192:195], v[128:131], v[96:111]
    buffer_load_dwordx4 v3, s[12:15], s79 offen offset:3072 sc1 lds
    v_rcp_f32_e64 v166, v166
    v_mfma_f32_32x32x16_bf16 v[112:127], a[196:199], v[128:131], v[112:127]
    ds_read2st64_b32 v[128:129], v21 offset0:0 offset1:1
    v_rcp_f32 v167, v167
    v_mul_f32 v168, v168, v164
    v_mul_f32 v169, v169, v165
    v_mul_f32 v170, v170, v166
    v_mfma_f32_32x32x16_bf16 v[96:111], a[200:203], v[132:135], v[96:111]
    ds_read2st64_b32 v[130:131], v26 offset0:0 offset1:1
    v_mul_f32_e64 v171, v171, v167
    v_cvt_pk_bf16_f32 v172, v168, v169
    v_cvt_pk_bf16_f32 v173, v170, v171
    v_mul_f32 v164, v76, v76
    v_mul_f32 v165, v77, v77
    v_mfma_f32_32x32x16_bf16 v[112:127], a[204:207], v[132:135], v[112:127]
    ds_read2st64_b32 v[132:133], v21 offset0:4 offset1:5
    v_mul_f32 v166, v78, v78
    v_mul_f32 v167, v79, v79
    v_fma_f32 v164, v164, v15, v14
    v_fma_f32 v165, v165, v15, v14
    v_fma_f32 v166, v166, v15, v14
    v_mfma_f32_32x32x16_bf16 v[96:111], a[208:211], v[136:139], v[96:111]
    ds_read2st64_b32 v[134:135], v26 offset0:4 offset1:5
    v_fma_f32 v167, v167, v15, v14
    v_mul_f32 v164, v164, v76
    v_mul_f32 v165, v165, v77
    v_mul_f32 v166, v166, v78
    v_mul_f32 v167, v167, v79
    v_mfma_f32_32x32x16_bf16 v[112:127], a[212:215], v[136:139], v[112:127]
    ds_read2st64_b32 v[136:137], v21 offset0:8 offset1:9
    v_exp_f32 v164, v164
    v_mul_f32 v168, v76, v92
    v_mfma_f32_32x32x16_bf16 v[96:111], a[216:219], v[140:143], v[96:111]
    ds_read2st64_b32 v[138:139], v26 offset0:8 offset1:9
    v_exp_f32 v165, v165
    v_mul_f32 v169, v77, v93
    v_exp_f32_e64 v166, v166
    v_mfma_f32_32x32x16_bf16 v[112:127], a[220:223], v[140:143], v[112:127]
    ds_read2st64_b32 v[140:141], v21 offset0:12 offset1:13
    v_mul_f32 v170, v78, v94
    v_exp_f32 v167, v167
    v_mul_f32_e64 v171, v79, v95
    v_fma_f32 v164, v164, v16, v16
    v_mfma_f32_32x32x16_bf16 v[96:111], a[224:227], v[160:163], v[96:111]
    ds_read2st64_b32 v[142:143], v26 offset0:12 offset1:13
    v_fma_f32 v165, v165, v16, v16
    v_fma_f32 v166, v166, v16, v16
    v_fma_f32 v167, v167, v16, v16
    v_rcp_f32_e64 v164, v164
    v_mfma_f32_32x32x16_bf16 v[112:127], a[228:231], v[160:163], v[112:127]
    v_rcp_f32 v165, v165
    v_rcp_f32 v166, v166
    v_rcp_f32 v167, v167
    v_mul_f32 v168, v168, v164
    v_mul_f32 v169, v169, v165
    v_mul_f32 v170, v170, v166
    v_mul_f32_e64 v171, v171, v167
    v_cvt_pk_bf16_f32 v174, v168, v169
    v_cvt_pk_bf16_f32 v175, v170, v171
    buffer_store_dwordx4 v[172:175], v24, s[12:15], 0 offen offset:512 sc1
    v_add_u32 v24, 114688, v24
    s_waitcnt lgkmcnt(6)
    v_mfma_f32_32x32x16_bf16 v[64:79], a[0:3], v[128:131], 0
    ds_read2st64_b32 v[156:157], v21 offset0:28 offset1:29
    s_add_u32 m0, s89, 0
    s_add_u32 s79, s45, 24576
    buffer_load_dwordx4 v3, s[12:15], s79 offen sc1 lds
    v_mfma_f32_32x32x16_bf16 v[80:95], a[4:7], v[128:131], 0
    ds_read2st64_b32 v[158:159], v26 offset0:28 offset1:29
    s_waitcnt lgkmcnt(6)
    v_mfma_f32_32x32x16_bf16 v[64:79], a[8:11], v[132:135], v[64:79]
    ds_read2st64_b32 v[128:129], v21 offset0:32 offset1:33
    buffer_load_dwordx4 v3, s[12:15], s79 offen offset:1024 sc1 lds
    v_mfma_f32_32x32x16_bf16 v[80:95], a[12:15], v[132:135], v[80:95]
    ds_read2st64_b32 v[130:131], v26 offset0:32 offset1:33
    v_mul_f32 v164, v96, v96
    v_mul_f32 v165, v97, v97
    v_mul_f32 v166, v98, v98
    v_mul_f32 v167, v99, v99
    v_fma_f32 v164, v164, v10, v9
    s_waitcnt lgkmcnt(6)
    v_mfma_f32_32x32x16_bf16 v[64:79], a[16:19], v[136:139], v[64:79]
    ds_read2st64_b32 v[132:133], v21 offset0:36 offset1:37
    v_fma_f32 v165, v165, v10, v9
    v_fma_f32 v166, v166, v10, v9
    v_fma_f32 v167, v167, v10, v9
    v_mul_f32 v164, v164, v96
    v_mul_f32 v165, v165, v97
    v_mfma_f32_32x32x16_bf16 v[80:95], a[20:23], v[136:139], v[80:95]
    ds_read2st64_b32 v[134:135], v26 offset0:36 offset1:37
    buffer_load_dwordx4 v3, s[12:15], s79 offen offset:2048 sc1 lds
    v_mul_f32 v166, v166, v98
    s_waitcnt lgkmcnt(6)
    v_mfma_f32_32x32x16_bf16 v[64:79], a[24:27], v[140:143], v[64:79]
    ds_read2st64_b32 v[136:137], v21 offset0:40 offset1:41
    v_mul_f32 v167, v167, v99
    v_exp_f32 v164, v164
    v_mul_f32_e64 v168, v96, v112
    v_mfma_f32_32x32x16_bf16 v[80:95], a[28:31], v[140:143], v[80:95]
    ds_read2st64_b32 v[138:139], v26 offset0:40 offset1:41
    buffer_load_dwordx4 v3, s[12:15], s79 offen offset:3072 sc1 lds
    v_exp_f32_e64 v165, v165
    v_mfma_f32_32x32x16_bf16 v[64:79], a[32:35], v[144:147], v[64:79]
    ds_read2st64_b32 v[140:141], v21 offset0:44 offset1:45
    v_mul_f32 v169, v97, v113
    v_exp_f32 v166, v166
    v_mul_f32_e64 v170, v98, v114
    v_mfma_f32_32x32x16_bf16 v[80:95], a[36:39], v[144:147], v[80:95]
    ds_read2st64_b32 v[142:143], v26 offset0:44 offset1:45
    v_exp_f32 v167, v167
    v_mul_f32 v171, v99, v115
    v_fma_f32 v164, v164, v11, v11
    v_fma_f32 v165, v165, v11, v11
    v_mfma_f32_32x32x16_bf16 v[64:79], a[40:43], v[148:151], v[64:79]
    ds_read2st64_b32 v[144:145], v21 offset0:48 offset1:49
    s_add_u32 m0, s89, 4096
    s_add_u32 s79, s45, 28672
    buffer_load_dwordx4 v3, s[12:15], s79 offen sc1 lds
    v_mfma_f32_32x32x16_bf16 v[80:95], a[44:47], v[148:151], v[80:95]
    ds_read2st64_b32 v[146:147], v26 offset0:48 offset1:49
    s_waitcnt lgkmcnt(8)
    v_fma_f32 v166, v166, v11, v11
    v_fma_f32 v167, v167, v11, v11
    v_rcp_f32 v164, v164
    v_mfma_f32_32x32x16_bf16 v[64:79], a[48:51], v[152:155], v[64:79]
    ds_read2st64_b32 v[148:149], v21 offset0:52 offset1:53
    buffer_load_dwordx4 v3, s[12:15], s79 offen offset:1024 sc1 lds
    v_rcp_f32_e64 v165, v165
    v_mfma_f32_32x32x16_bf16 v[80:95], a[52:55], v[152:155], v[80:95]
    ds_read2st64_b32 v[150:151], v26 offset0:52 offset1:53
    v_rcp_f32 v166, v166
    v_rcp_f32 v167, v167
    v_mul_f32_e64 v168, v168, v164
    v_mfma_f32_32x32x16_bf16 v[64:79], a[56:59], v[156:159], v[64:79]
    ds_read2st64_b32 v[152:153], v21 offset0:56 offset1:57
    v_mul_f32 v169, v169, v165
    v_mul_f32 v170, v170, v166
    v_mul_f32_e64 v171, v171, v167
    v_cvt_pk_bf16_f32 v172, v168, v169
    v_cvt_pk_bf16_f32 v173, v170, v171
    v_mfma_f32_32x32x16_bf16 v[80:95], a[60:63], v[156:159], v[80:95]
    ds_read2st64_b32 v[154:155], v26 offset0:56 offset1:57
    buffer_load_dwordx4 v3, s[12:15], s79 offen offset:2048 sc1 lds
    v_mul_f32 v164, v100, v100
    v_mul_f32 v165, v101, v101
    v_mfma_f32_32x32x16_bf16 v[64:79], a[64:67], v[128:131], v[64:79]
    ds_read2st64_b32 v[156:157], v21 offset0:60 offset1:61
    v_mul_f32 v166, v102, v102
    v_mul_f32 v167, v103, v103
    v_fma_f32 v164, v164, v10, v9
    v_fma_f32 v165, v165, v10, v9
    v_fma_f32 v166, v166, v10, v9
    v_mfma_f32_32x32x16_bf16 v[80:95], a[68:71], v[128:131], v[80:95]
    ds_read2st64_b32 v[158:159], v26 offset0:60 offset1:61
    s_waitcnt lgkmcnt(8)
    buffer_load_dwordx4 v3, s[12:15], s79 offen offset:3072 sc1 lds
    v_fma_f32 v167, v167, v10, v9
    v_mfma_f32_32x32x16_bf16 v[64:79], a[72:75], v[132:135], v[64:79]
    ds_read2st64_b32 v[128:129], v21 offset0:64 offset1:65
    v_mul_f32 v164, v164, v100
    v_mul_f32 v165, v165, v101
    v_mul_f32 v166, v166, v102
    v_mul_f32_e64 v167, v167, v103
    v_mfma_f32_32x32x16_bf16 v[80:95], a[76:79], v[132:135], v[80:95]
    ds_read2st64_b32 v[130:131], v26 offset0:64 offset1:65
    v_exp_f32 v164, v164
    v_mul_f32 v168, v100, v116
    v_exp_f32_e64 v165, v165
    v_mfma_f32_32x32x16_bf16 v[64:79], a[80:83], v[136:139], v[64:79]
    ds_read2st64_b32 v[132:133], v21 offset0:68 offset1:69
    buffer_load_dwordx2 v[60:61], v22, s[12:15], 0 offen offset:512 sc1
    v_mul_f32_e64 v169, v101, v117
    v_mfma_f32_32x32x16_bf16 v[80:95], a[84:87], v[136:139], v[80:95]
    ds_read2st64_b32 v[134:135], v26 offset0:68 offset1:69
    v_exp_f32 v166, v166
    v_mul_f32 v170, v102, v118
    v_exp_f32_e64 v167, v167
    v_mfma_f32_32x32x16_bf16 v[64:79], a[88:91], v[140:143], v[64:79]
    ds_read2st64_b32 v[136:137], v21 offset0:72 offset1:73
    s_add_u32 m0, s89, 8192
    s_add_u32 s79, s45, 32768
    buffer_load_dwordx4 v3, s[12:15], s79 offen sc1 lds
    v_mfma_f32_32x32x16_bf16 v[80:95], a[92:95], v[140:143], v[80:95]
    ds_read2st64_b32 v[138:139], v26 offset0:72 offset1:73
    s_waitcnt lgkmcnt(8)
    v_mul_f32 v171, v103, v119
    v_fma_f32 v164, v164, v11, v11
    v_fma_f32 v165, v165, v11, v11
    v_fma_f32 v166, v166, v11, v11
    v_mfma_f32_32x32x16_bf16 v[64:79], a[96:99], v[144:147], v[64:79]
    ds_read2st64_b32 v[140:141], v21 offset0:76 offset1:77
    s_waitcnt vmcnt(10)
    buffer_atomic_add v2, v8, s[12:15], s82 offen
    s_addk_i32 s82, 2048
    v_mfma_f32_32x32x16_bf16 v[80:95], a[100:103], v[144:147], v[80:95]
    ds_read2st64_b32 v[142:143], v26 offset0:76 offset1:77
    buffer_load_dwordx4 v3, s[12:15], s79 offen offset:1024 sc1 lds
    v_fma_f32 v167, v167, v11, v11
    v_mfma_f32_32x32x16_bf16 v[64:79], a[104:107], v[148:151], v[64:79]
    ds_read2st64_b32 v[144:145], v21 offset0:80 offset1:81
    v_rcp_f32 v164, v164
    v_rcp_f32 v165, v165
    v_mfma_f32_32x32x16_bf16 v[80:95], a[108:111], v[148:151], v[80:95]
    ds_read2st64_b32 v[146:147], v26 offset0:80 offset1:81
    buffer_load_dwordx4 v3, s[12:15], s79 offen offset:2048 sc1 lds
    v_rcp_f32_e64 v166, v166
    v_mfma_f32_32x32x16_bf16 v[64:79], a[112:115], v[152:155], v[64:79]
    ds_read2st64_b32 v[148:149], v21 offset0:84 offset1:85
    v_rcp_f32 v167, v167
    v_mul_f32 v168, v168, v164
    v_mul_f32 v169, v169, v165
    v_mul_f32 v170, v170, v166
    v_mfma_f32_32x32x16_bf16 v[80:95], a[116:119], v[152:155], v[80:95]
    ds_read2st64_b32 v[150:151], v26 offset0:84 offset1:85
    s_waitcnt lgkmcnt(8)
    v_mul_f32_e64 v171, v171, v167
    v_cvt_pk_bf16_f32 v174, v168, v169
    v_cvt_pk_bf16_f32 v175, v170, v171
    v_mfma_f32_32x32x16_bf16 v[64:79], a[120:123], v[156:159], v[64:79]
    ds_read2st64_b32 v[152:153], v21 offset0:88 offset1:89
    buffer_load_dwordx4 v3, s[12:15], s79 offen offset:3072 sc1 lds
    s_barrier
    v_mfma_f32_32x32x16_bf16 v[80:95], a[124:127], v[156:159], v[80:95]
    ds_read2st64_b32 v[154:155], v26 offset0:88 offset1:89
    buffer_store_dwordx4 v[172:175], v24, s[12:15], 0 offen offset:0 sc1
    v_mfma_f32_32x32x16_bf16 v[64:79], a[128:131], v[128:131], v[64:79]
    ds_read2st64_b32 v[156:157], v21 offset0:92 offset1:93
    s_add_u32 m0, s89, 12288
    s_add_u32 s79, s45, 36864
    buffer_load_dwordx4 v3, s[12:15], s79 offen sc1 lds
    v_mfma_f32_32x32x16_bf16 v[80:95], a[132:135], v[128:131], v[80:95]
    ds_read2st64_b32 v[158:159], v26 offset0:92 offset1:93
    v_mul_f32 v164, v104, v104
    v_mul_f32 v165, v105, v105
    v_mul_f32 v166, v106, v106
    v_mul_f32 v167, v107, v107
    v_fma_f32 v164, v164, v10, v9
    v_mfma_f32_32x32x16_bf16 v[64:79], a[136:139], v[132:135], v[64:79]
    ds_read2st64_b32 v[128:129], v21 offset0:96 offset1:97
    v_fma_f32 v165, v165, v10, v9
    v_fma_f32 v166, v166, v10, v9
    v_fma_f32 v167, v167, v10, v9
    v_mul_f32 v164, v164, v104
    v_mul_f32 v165, v165, v105
    v_mfma_f32_32x32x16_bf16 v[80:95], a[140:143], v[132:135], v[80:95]
    ds_read2st64_b32 v[130:131], v26 offset0:96 offset1:97
    s_waitcnt lgkmcnt(8)
    buffer_load_dwordx4 v3, s[12:15], s79 offen offset:1024 sc1 lds
    v_mul_f32 v166, v166, v106
    v_mfma_f32_32x32x16_bf16 v[64:79], a[144:147], v[136:139], v[64:79]
    ds_read2st64_b32 v[132:133], v21 offset0:100 offset1:101
    v_mul_f32 v167, v167, v107
    v_exp_f32 v164, v164
    v_mul_f32_e64 v168, v104, v120
    v_mfma_f32_32x32x16_bf16 v[80:95], a[148:151], v[136:139], v[80:95]
    ds_read2st64_b32 v[134:135], v26 offset0:100 offset1:101
    buffer_load_dwordx4 v3, s[12:15], s79 offen offset:2048 sc1 lds
    v_exp_f32_e64 v165, v165
    v_mfma_f32_32x32x16_bf16 v[64:79], a[152:155], v[140:143], v[64:79]
    ds_read2st64_b32 v[136:137], v21 offset0:104 offset1:105
    v_mul_f32 v169, v105, v121
    v_exp_f32 v166, v166
    v_mul_f32_e64 v170, v106, v122
    v_mfma_f32_32x32x16_bf16 v[80:95], a[156:159], v[140:143], v[80:95]
    ds_read2st64_b32 v[138:139], v26 offset0:104 offset1:105
    v_exp_f32 v167, v167
    v_mul_f32 v171, v107, v123
    v_fma_f32 v164, v164, v11, v11
    v_fma_f32 v165, v165, v11, v11
    v_mfma_f32_32x32x16_bf16 v[64:79], a[160:163], v[144:147], v[64:79]
    ds_read2st64_b32 v[140:141], v21 offset0:108 offset1:109
    buffer_load_dwordx4 v3, s[12:15], s79 offen offset:3072 sc1 lds
    v_fma_f32 v166, v166, v11, v11
    v_fma_f32 v167, v167, v11, v11
    v_mfma_f32_32x32x16_bf16 v[80:95], a[164:167], v[144:147], v[80:95]
    ds_read2st64_b32 v[142:143], v26 offset0:108 offset1:109
    s_waitcnt lgkmcnt(8)
    v_rcp_f32 v164, v164
    v_rcp_f32_e64 v165, v165
    v_mfma_f32_32x32x16_bf16 v[64:79], a[168:171], v[148:151], v[64:79]
    s_add_u32 s79, s45, 45056
    buffer_load_dwordx4 v[176:179], v3, s[12:15], s79 offen sc1
    ds_read2st64_b32 v[144:145], v21 offset0:128 offset1:129
    v_mfma_f32_32x32x16_bf16 v[80:95], a[172:175], v[148:151], v[80:95]
    ds_read2st64_b32 v[146:147], v26 offset0:128 offset1:129
    ds_read2st64_b32 v[148:149], v21 offset0:132 offset1:133
    v_rcp_f32 v166, v166
    v_rcp_f32 v167, v167
    v_mfma_f32_32x32x16_bf16 v[64:79], a[176:179], v[152:155], v[64:79]
    ds_read2st64_b32 v[150:151], v26 offset0:132 offset1:133
    v_mul_f32 v168, v168, v164
    v_mul_f32 v169, v169, v165
    v_mul_f32 v170, v170, v166
    v_mul_f32 v171, v171, v167
    v_cvt_pk_bf16_f32 v172, v168, v169
    v_mfma_f32_32x32x16_bf16 v[80:95], a[180:183], v[152:155], v[80:95]
    buffer_load_dwordx4 v[180:183], v3, s[12:15], s79 offen offset:1024 sc1
    ds_read2st64_b32 v[152:153], v21 offset0:136 offset1:137
    v_cvt_pk_bf16_f32 v173, v170, v171
    v_mul_f32_e64 v164, v108, v108
    v_mfma_f32_32x32x16_bf16 v[64:79], a[184:187], v[156:159], v[64:79]
    ds_read2st64_b32 v[154:155], v26 offset0:136 offset1:137
    v_mul_f32 v165, v109, v109
    v_mul_f32 v166, v110, v110
    v_mul_f32 v167, v111, v111
    v_fma_f32 v164, v164, v10, v9
    v_fma_f32 v165, v165, v10, v9
    v_mfma_f32_32x32x16_bf16 v[80:95], a[188:191], v[156:159], v[80:95]
    s_waitcnt lgkmcnt(8)
    buffer_load_dwordx4 v[184:187], v3, s[12:15], s79 offen offset:2048 sc1
    v_fma_f32 v166, v166, v10, v9
    v_fma_f32 v167, v167, v10, v9
    v_mfma_f32_32x32x16_bf16 v[64:79], a[192:195], v[128:131], v[64:79]
    v_mul_f32 v164, v164, v108
    v_mul_f32 v165, v165, v109
    v_mul_f32 v166, v166, v110
    v_mul_f32 v167, v167, v111
    v_exp_f32 v164, v164
    v_mfma_f32_32x32x16_bf16 v[80:95], a[196:199], v[128:131], v[80:95]
    s_waitcnt vmcnt(13)
    v_cmp_ne_u32 vcc, s32, v61
    s_cbranch_vccnz L_sslow_13
L_sdone_14:
    ds_read2st64_b32 v[128:129], v21 offset0:112 offset1:113
    v_mul_f32 v168, v108, v124
    v_exp_f32 v165, v165
    v_mfma_f32_32x32x16_bf16 v[64:79], a[200:203], v[132:135], v[64:79]
    buffer_load_dwordx4 v[56:59], v3, s[12:15], s79 offen offset:3072 sc1
    ds_read2st64_b32 v[130:131], v26 offset0:112 offset1:113
    v_perm_b32 v160, v60, v60, s93
    v_cvt_f32_f16 v60, v60
    v_mul_f32 v61, v60, v60
    v_mfma_f32_32x32x16_bf16 v[80:95], a[204:207], v[132:135], v[80:95]
    ds_read2st64_b32 v[132:133], v21 offset0:116 offset1:117
    v_mul_f32 v14, 0xc0135761, v60
    v_rcp_f32 v16, v61
    v_mul_f32 v15, v61, v14
    v_mul_f32 v15, 0x3d372713, v15
    v_mfma_f32_32x32x16_bf16 v[64:79], a[208:211], v[136:139], v[64:79]
    buffer_load_dwordx2 v[62:63], v22, s[12:15], 0 offen offset:768 sc1
    ds_read2st64_b32 v[134:135], v26 offset0:116 offset1:117
    v_mul_f32 v169, v109, v125
    v_mfma_f32_32x32x16_bf16 v[80:95], a[212:215], v[136:139], v[80:95]
    s_waitcnt lgkmcnt(10)
    ds_read2st64_b32 v[136:137], v21 offset0:120 offset1:121
    v_exp_f32 v166, v166
    v_mul_f32 v170, v110, v126
    v_mfma_f32_32x32x16_bf16 v[64:79], a[216:219], v[140:143], v[64:79]
    ds_read2st64_b32 v[138:139], v26 offset0:120 offset1:121
    v_exp_f32 v167, v167
    v_mul_f32 v171, v111, v127
    v_fma_f32 v164, v164, v11, v11
    v_fma_f32 v165, v165, v11, v11
    v_mfma_f32_32x32x16_bf16 v[80:95], a[220:223], v[140:143], v[80:95]
    ds_read2st64_b32 v[140:141], v21 offset0:124 offset1:125
L_pad4:
    s_cbranch_execz L_walk_back
    v_fma_f32 v166, v166, v11, v11
    v_fma_f32 v167, v167, v11, v11
    v_rcp_f32 v164, v164
    v_mfma_f32_32x32x16_bf16 v[64:79], a[224:227], v[160:163], v[64:79]
    v_mov_b32_e64 v7, 0
    buffer_atomic_add v7, v252, s[12:15], s42 offen sc0
    ds_read2st64_b32 v[142:143], v26 offset0:124 offset1:125
    v_mfma_f32_32x32x16_bf16 v[80:95], a[228:231], v[160:163], v[80:95]
    v_rcp_f32 v165, v165
    v_rcp_f32 v166, v166
    v_rcp_f32 v167, v167
    v_mul_f32 v168, v168, v164
    v_mul_f32 v169, v169, v165
    v_mul_f32 v170, v170, v166
    v_mul_f32_e64 v171, v171, v167
    v_cvt_pk_bf16_f32 v174, v168, v169
    v_cvt_pk_bf16_f32 v175, v170, v171
    buffer_store_dwordx4 v[172:175], v24, s[12:15], 0 offen offset:512 sc1
    v_add_u32 v24, 114688, v24
    s_waitcnt lgkmcnt(6)
    v_mfma_f32_32x32x16_bf16 v[96:111], a[0:3], v[128:131], 0
    ds_read2st64_b32 v[156:157], v21 offset0:140 offset1:141
    v_mfma_f32_32x32x16_bf16 v[112:127], a[4:7], v[128:131], 0
    ds_read2st64_b32 v[158:159], v26 offset0:140 offset1:141
    s_waitcnt lgkmcnt(6)
    v_mfma_f32_32x32x16_bf16 v[96:111], a[8:11], v[132:135], v[96:111]
    ds_read2st64_b32 v[128:129], v21 offset0:144 offset1:145
    v_mul_f32 v164, v64, v64
    v_mul_f32 v165, v65, v65
    v_mul_f32 v166, v66, v66
    v_mul_f32 v167, v67, v67
    v_fma_f32 v164, v164, v15, v14
    v_fma_f32 v165, v165, v15, v14
    v_mfma_f32_32x32x16_bf16 v[112:127], a[12:15], v[132:135], v[112:127]
    ds_read2st64_b32 v[130:131], v26 offset0:144 offset1:145
    v_fma_f32 v166, v166, v15, v14
    v_fma_f32 v167, v167, v15, v14
    v_mul_f32 v164, v164, v64
    v_mul_f32 v165, v165, v65
    v_mul_f32_e64 v166, v166, v66
    v_mul_f32 v167, v167, v67
    s_waitcnt lgkmcnt(6)
    v_mfma_f32_32x32x16_bf16 v[96:111], a[16:19], v[136:139], v[96:111]
    ds_read2st64_b32 v[132:133], v21 offset0:148 offset1:149
    s_add_u32 s79, s45, 49152
    buffer_load_dwordx4 a[0:3], v3, s[12:15], s79 offen sc1
    v_exp_f32_e64 v164, v164
    v_mfma_f32_32x32x16_bf16 v[112:127], a[20:23], v[136:139], v[112:127]
    ds_read2st64_b32 v[134:135], v26 offset0:148 offset1:149
    v_mul_f32 v168, v64, v80
    v_exp_f32 v165, v165
    v_mul_f32 v169, v65, v81
    s_waitcnt lgkmcnt(6)
    v_mfma_f32_32x32x16_bf16 v[96:111], a[24:27], v[140:143], v[96:111]
    ds_read2st64_b32 v[136:137], v21 offset0:152 offset1:153
    buffer_load_dwordx4 a[4:7], v3, s[12:15], s79 offen offset:1024 sc1
    v_exp_f32 v166, v166
    v_mul_f32 v170, v66, v82
    v_mfma_f32_32x32x16_bf16 v[112:127], a[28:31], v[140:143], v[112:127]
    ds_read2st64_b32 v[138:139], v26 offset0:152 offset1:153
    v_exp_f32 v167, v167
    v_mul_f32 v171, v67, v83
    v_fma_f32 v164, v164, v16, v16
    v_fma_f32 v165, v165, v16, v16
    v_fma_f32 v166, v166, v16, v16
    v_mfma_f32_32x32x16_bf16 v[96:111], a[32:35], v[144:147], v[96:111]
    ds_read2st64_b32 v[140:141], v21 offset0:156 offset1:157
    buffer_load_dwordx4 a[8:11], v3, s[12:15], s79 offen offset:2048 sc1
    v_fma_f32 v167, v167, v16, v16
    v_rcp_f32_e64 v164, v164
    v_mfma_f32_32x32x16_bf16 v[112:127], a[36:39], v[144:147], v[112:127]
    ds_read2st64_b32 v[142:143], v26 offset0:156 offset1:157
    v_rcp_f32 v165, v165
    v_rcp_f32 v166, v166
    v_rcp_f32_e64 v167, v167
    v_mfma_f32_32x32x16_bf16 v[96:111], a[40:43], v[148:151], v[96:111]
    ds_read2st64_b32 v[144:145], v21 offset0:160 offset1:161
    v_mul_f32 v168, v168, v164
    v_mul_f32 v169, v169, v165
    v_mul_f32 v170, v170, v166
    v_mul_f32 v171, v171, v167
    v_cvt_pk_bf16_f32 v172, v168, v169
    v_cvt_pk_bf16_f32 v173, v170, v171
    v_mfma_f32_32x32x16_bf16 v[112:127], a[44:47], v[148:151], v[112:127]
    ds_read2st64_b32 v[146:147], v26 offset0:160 offset1:161
    s_waitcnt lgkmcnt(8)
    buffer_load_dwordx4 a[12:15], v3, s[12:15], s79 offen offset:3072 sc1
    v_mul_f32 v164, v68, v68
    v_mul_f32_e64 v165, v69, v69
    v_mfma_f32_32x32x16_bf16 v[96:111], a[48:51], v[152:155], v[96:111]
    ds_read2st64_b32 v[148:149], v21 offset0:164 offset1:165
    v_mul_f32 v166, v70, v70
    v_mul_f32 v167, v71, v71
    v_fma_f32 v164, v164, v15, v14
    v_fma_f32 v165, v165, v15, v14
    v_fma_f32 v166, v166, v15, v14
    v_fma_f32 v167, v167, v15, v14
    v_mfma_f32_32x32x16_bf16 v[112:127], a[52:55], v[152:155], v[112:127]
    ds_read2st64_b32 v[150:151], v26 offset0:164 offset1:165
    s_add_u32 s79, s45, 53248
    buffer_load_dwordx4 a[16:19], v3, s[12:15], s79 offen sc1
    v_mul_f32 v164, v164, v68
    v_mul_f32 v165, v165, v69
    v_mfma_f32_32x32x16_bf16 v[96:111], a[56:59], v[156:159], v[96:111]
    ds_read2st64_b32 v[152:153], v21 offset0:168 offset1:169
    v_mul_f32 v166, v166, v70
    v_mul_f32 v167, v167, v71
    v_exp_f32 v164, v164
    v_mul_f32 v168, v68, v84
    v_mfma_f32_32x32x16_bf16 v[112:127], a[60:63], v[156:159], v[112:127]
    ds_read2st64_b32 v[154:155], v26 offset0:168 offset1:169
    v_exp_f32 v165, v165
    v_mul_f32 v169, v69, v85
    v_exp_f32 v166, v166
    v_mul_f32 v170, v70, v86
    v_mfma_f32_32x32x16_bf16 v[96:111], a[64:67], v[128:131], v[96:111]
    ds_read2st64_b32 v[156:157], v21 offset0:172 offset1:173
    buffer_load_dwordx4 a[20:23], v3, s[12:15], s79 offen offset:1024 sc1
    v_exp_f32_e64 v167, v167
    v_mul_f32 v171, v71, v87
    v_mfma_f32_32x32x16_bf16 v[112:127], a[68:71], v[128:131], v[112:127]
    ds_read2st64_b32 v[158:159], v26 offset0:172 offset1:173
    s_waitcnt lgkmcnt(8)
    v_fma_f32 v164, v164, v16, v16
    v_fma_f32 v165, v165, v16, v16
    v_fma_f32 v166, v166, v16, v16
    v_fma_f32 v167, v167, v16, v16
    v_mfma_f32_32x32x16_bf16 v[96:111], a[72:75], v[132:135], v[96:111]
    ds_read2st64_b32 v[128:129], v21 offset0:176 offset1:177
    buffer_load_dwordx4 a[24:27], v3, s[12:15], s79 offen offset:2048 sc1
    v_rcp_f32_e64 v164, v164
    v_mfma_f32_32x32x16_bf16 v[112:127], a[76:79], v[132:135], v[112:127]
    ds_read2st64_b32 v[130:131], v26 offset0:176 offset1:177
    v_rcp_f32 v165, v165
    v_rcp_f32 v166, v166
    v_rcp_f32_e64 v167, v167
    v_mfma_f32_32x32x16_bf16 v[96:111], a[80:83], v[136:139], v[96:111]
    ds_read2st64_b32 v[132:133], v21 offset0:180 offset1:181
    buffer_load_dwordx4 a[28:31], v3, s[12:15], s79 offen offset:3072 sc1
    v_mul_f32 v168, v168, v164
    v_mul_f32 v169, v169, v165
    v_mul_f32_e64 v170, v170, v166
    v_mfma_f32_32x32x16_bf16 v[112:127], a[84:87], v[136:139], v[112:127]
    ds_read2st64_b32 v[134:135], v26 offset0:180 offset1:181
    s_waitcnt vmcnt(8)
    buffer_atomic_add v2, v8, s[12:15], s82 offen
    s_addk_i32 s82, 2048
    v_mul_f32_e64 v171, v171, v167
    v_mfma_f32_32x32x16_bf16 v[96:111], a[88:91], v[140:143], v[96:111]
    ds_read2st64_b32 v[136:137], v21 offset0:184 offset1:185
    v_cmp_eq_u32 vcc, s47, v7
    s_cbranch_vccz L_slow_17x
L_pdone_18:
    s_add_u32 s42, s42, 2048
    v_cvt_pk_bf16_f32 v174, v168, v169
    v_cvt_pk_bf16_f32 v175, v170, v171
    v_mfma_f32_32x32x16_bf16 v[112:127], a[92:95], v[140:143], v[112:127]
    ds_read2st64_b32 v[138:139], v26 offset0:184 offset1:185
    s_waitcnt lgkmcnt(8)
    buffer_load_dwordx4 a[32:35], v44, s[12:15], 0 offen sc1
    v_mfma_f32_32x32x16_bf16 v[96:111], a[96:99], v[144:147], v[96:111]
    ds_read2st64_b32 v[140:141], v21 offset0:188 offset1:189
    buffer_store_dwordx4 v[172:175], v24, s[12:15], 0 offen offset:0 sc1
    v_mul_f32 v164, v72, v72
    v_mfma_f32_32x32x16_bf16 v[112:127], a[100:103], v[144:147], v[112:127]
    ds_read2st64_b32 v[142:143], v26 offset0:188 offset1:189
    buffer_load_dwordx4 a[36:39], v44, s[12:15], 0 offen offset:1024 sc1
    v_mul_f32 v165, v73, v73
    v_mul_f32 v166, v74, v74
    v_mul_f32_e64 v167, v75, v75
    v_mfma_f32_32x32x16_bf16 v[96:111], a[104:107], v[148:151], v[96:111]
    ds_read2st64_b32 v[144:145], v21 offset0:192 offset1:193
    v_fma_f32 v164, v164, v15, v14
    v_fma_f32 v165, v165, v15, v14
    v_fma_f32 v166, v166, v15, v14
    v_fma_f32 v167, v167, v15, v14
    v_mul_f32 v164, v164, v72
    v_mul_f32 v165, v165, v73
    v_mfma_f32_32x32x16_bf16 v[112:127], a[108:111], v[148:151], v[112:127]
    ds_read2st64_b32 v[146:147], v26 offset0:192 offset1:193
    buffer_load_dwordx4 a[40:43], v44, s[12:15], 0 offen offset:2048 sc1
    v_mul_f32 v166, v166, v74
    v_mul_f32 v167, v167, v75
    v_mfma_f32_32x32x16_bf16 v[96:111], a[112:115], v[152:155], v[96:111]
    ds_read2st64_b32 v[148:149], v21 offset0:196 offset1:197
    v_exp_f32 v164, v164
    v_mul_f32 v168, v72, v88
    v_exp_f32 v165, v165
    v_mul_f32 v169, v73, v89
    v_mfma_f32_32x32x16_bf16 v[112:127], a[116:119], v[152:155], v[112:127]
    ds_read2st64_b32 v[150:151], v26 offset0:196 offset1:197
    s_waitcnt lgkmcnt(8)
    v_exp_f32 v166, v166
    v_mul_f32 v170, v74, v90
    v_exp_f32 v167, v167
    v_mfma_f32_32x32x16_bf16 v[96:111], a[120:123], v[156:159], v[96:111]
    ds_read2st64_b32 v[152:153], v21 offset0:200 offset1:201
    buffer_load_dwordx4 a[44:47], v44, s[12:15], 0 offen offset:3072 sc1
    v_mul_f32_e64 v171, v75, v91
    v_fma_f32 v164, v164, v16, v16
    v_fma_f32 v165, v165, v16, v16
    v_mfma_f32_32x32x16_bf16 v[112:127], a[124:127], v[156:159], v[112:127]
    ds_read2st64_b32 v[154:155], v26 offset0:200 offset1:201
    v_fma_f32 v166, v166, v16, v16
    v_fma_f32 v167, v167, v16, v16
    v_rcp_f32 v164, v164
    v_rcp_f32 v165, v165
    v_mfma_f32_32x32x16_bf16 v[96:111], a[128:131], v[128:131], v[96:111]
    ds_read2st64_b32 v[156:157], v21 offset0:204 offset1:205
    buffer_load_dwordx4 a[48:51], v44, s[12:15], s38 offen offset:2048 sc1
    v_rcp_f32_e64 v166, v166
    v_mfma_f32_32x32x16_bf16 v[112:127], a[132:135], v[128:131], v[112:127]
    ds_read2st64_b32 v[158:159], v26 offset0:204 offset1:205
    v_rcp_f32 v167, v167
    v_mul_f32 v168, v168, v164
    v_mul_f32 v169, v169, v165
    v_mul_f32 v170, v170, v166
    v_mul_f32_e64 v171, v171, v167
    v_mfma_f32_32x32x16_bf16 v[96:111], a[136:139], v[132:135], v[96:111]
    ds_read2st64_b32 v[128:129], v21 offset0:208 offset1:209
    buffer_load_dwordx4 a[52:55], v44, s[12:15], s38 offen offset:3072 sc1
    v_cvt_pk_bf16_f32 v172, v168, v169
    v_cvt_pk_bf16_f32 v173, v170, v171
    v_mul_f32_e64 v164, v76, v76
    v_mfma_f32_32x32x16_bf16 v[112:127], a[140:143], v[132:135], v[112:127]
    ds_read2st64_b32 v[130:131], v26 offset0:208 offset1:209
    s_waitcnt lgkmcnt(8)
    v_mul_f32 v165, v77, v77
    v_mul_f32 v166, v78, v78
    v_mul_f32 v167, v79, v79
    v_fma_f32 v164, v164, v15, v14
    v_fma_f32 v165, v165, v15, v14
    v_mfma_f32_32x32x16_bf16 v[96:111], a[144:147], v[136:139], v[96:111]
    ds_read2st64_b32 v[132:133], v21 offset0:212 offset1:213
    v_fma_f32 v166, v166, v15, v14
    v_fma_f32 v167, v167, v15, v14
    v_mul_f32 v164, v164, v76
    v_mul_f32 v165, v165, v77
    v_mul_f32 v166, v166, v78
    v_mul_f32 v167, v167, v79
    v_mfma_f32_32x32x16_bf16 v[112:127], a[148:151], v[136:139], v[112:127]
    ds_read2st64_b32 v[134:135], v26 offset0:212 offset1:213
    buffer_load_dwordx4 a[56:59], v44, s[12:15], s39 offen sc1
    v_exp_f32 v164, v164
    v_mul_f32 v168, v76, v92
    v_mfma_f32_32x32x16_bf16 v[96:111], a[152:155], v[140:143], v[96:111]
    ds_read2st64_b32 v[136:137], v21 offset0:216 offset1:217
    v_exp_f32 v165, v165
    v_mul_f32 v169, v77, v93
    v_exp_f32 v166, v166
    v_mul_f32 v170, v78, v94
    v_mfma_f32_32x32x16_bf16 v[112:127], a[156:159], v[140:143], v[112:127]
    ds_read2st64_b32 v[138:139], v26 offset0:216 offset1:217
    buffer_load_dwordx4 a[60:63], v44, s[12:15], s39 offen offset:1024 sc1
    v_exp_f32 v167, v167
    v_mul_f32 v171, v79, v95
    v_mfma_f32_32x32x16_bf16 v[96:111], a[160:163], v[144:147], v[96:111]
    ds_read2st64_b32 v[140:141], v21 offset0:220 offset1:221
    v_fma_f32 v164, v164, v16, v16
    v_fma_f32 v165, v165, v16, v16
    v_fma_f32 v166, v166, v16, v16
    v_fma_f32 v167, v167, v16, v16
    v_rcp_f32_e64 v164, v164
    v_mfma_f32_32x32x16_bf16 v[112:127], a[164:167], v[144:147], v[112:127]
    ds_read2st64_b32 v[142:143], v26 offset0:220 offset1:221
    s_waitcnt lgkmcnt(8)
    v_rcp_f32 v165, v165
    v_rcp_f32_e64 v166, v166
    v_mfma_f32_32x32x16_bf16 v[96:111], a[168:171], v[148:151], v[96:111]
    buffer_load_dwordx4 a[64:67], v44, s[12:15], s37 offen sc1
    v_rcp_f32 v167, v167
    v_mul_f32 v168, v168, v164
    v_mul_f32_e64 v169, v169, v165
    v_mfma_f32_32x32x16_bf16 v[112:127], a[172:175], v[148:151], v[112:127]
    v_mul_f32 v170, v170, v166
    v_mul_f32 v171, v171, v167
    v_cvt_pk_bf16_f32 v174, v168, v169
    v_cvt_pk_bf16_f32 v175, v170, v171
    v_mfma_f32_32x32x16_bf16 v[96:111], a[176:179], v[152:155], v[96:111]
    buffer_load_dwordx4 a[68:71], v44, s[12:15], s37 offen offset:1024 sc1
    v_mfma_f32_32x32x16_bf16 v[112:127], a[180:183], v[152:155], v[112:127]
    buffer_store_dwordx4 v[172:175], v24, s[12:15], 0 offen offset:512 sc1
    v_add_u32 v24, 114688, v24
    v_mfma_f32_32x32x16_bf16 v[96:111], a[184:187], v[156:159], v[96:111]
    buffer_load_dwordx4 a[72:75], v44, s[12:15], s37 offen offset:2048 sc1
    v_mfma_f32_32x32x16_bf16 v[112:127], a[188:191], v[156:159], v[112:127]
    s_waitcnt lgkmcnt(2)
    v_mov_b32 v7, 0
    buffer_atomic_add v7, v252, s[12:15], s42 offen sc0
    v_mfma_f32_32x32x16_bf16 v[96:111], a[192:195], v[128:131], v[96:111]
    v_cmp_ne_u32 vcc, s32, v63
    s_cbranch_vccnz L_sslow_15
L_sdone_16:
    v_mfma_f32_32x32x16_bf16 v[112:127], a[196:199], v[128:131], v[112:127]
    buffer_load_dwordx4 a[76:79], v44, s[12:15], s37 offen offset:3072 sc1
    v_perm_b32 v160, v62, v62, s93
    v_cvt_f32_f16 v62, v62
    v_mul_f32 v63, v62, v62
    v_mul_f32 v9, 0xc0135761, v62
    v_rcp_f32_e64 v11, v63
    v_mfma_f32_32x32x16_bf16 v[96:111], a[200:203], v[132:135], v[96:111]
    v_mul_f32_e64 v10, v63, v9
    v_mul_f32 v10, 0x3d372713, v10
    v_mfma_f32_32x32x16_bf16 v[112:127], a[204:207], v[132:135], v[112:127]
    buffer_load_dwordx4 a[80:83], v44, s[12:15], s38 offen sc1
    v_mfma_f32_32x32x16_bf16 v[96:111], a[208:211], v[136:139], v[96:111]
    ds_read2st64_b32 v[50:51], v27 offset0:0 offset1:1
    v_mfma_f32_32x32x16_bf16 v[112:127], a[212:215], v[136:139], v[112:127]
    s_waitcnt lgkmcnt(1)
    v_mfma_f32_32x32x16_bf16 v[96:111], a[216:219], v[140:143], v[96:111]
    buffer_load_dwordx4 a[84:87], v44, s[12:15], s38 offen offset:1024 sc1
    v_add_u32 v44, 114688, v44
    ds_read2st64_b32 v[52:53], v27 offset0:112 offset1:113
    v_mfma_f32_32x32x16_bf16 v[112:127], a[220:223], v[140:143], v[112:127]
    v_mfma_f32_32x32x16_bf16 v[96:111], a[224:227], v[160:163], v[96:111]
    v_mfma_f32_32x32x16_bf16 v[112:127], a[228:231], v[160:163], v[112:127]
    ds_read_b128 a[128:131], v28 offset:0
    ds_read_b128 a[132:135], v28 offset:1024
    ds_read_b128 a[136:139], v28 offset:2048
    ds_read_b128 a[140:143], v28 offset:3072
    ds_read_b128 a[144:147], v28 offset:4096
    ds_read_b128 a[148:151], v28 offset:5120
    ds_read_b128 a[152:155], v28 offset:6144
    ds_read_b128 a[156:159], v28 offset:7168
    s_nop 2
    v_pk_mul_f32 v[164:165], v[96:97], v[96:97]
    v_pk_mul_f32 v[166:167], v[98:99], v[98:99]
    v_pk_mul_f32 v[168:169], v[100:101], v[100:101]
    v_pk_mul_f32 v[170:171], v[102:103], v[102:103]
    v_pk_fma_f32 v[164:165], v[164:165], v[10:11], v[8:9] op_sel:[0,0,1] op_sel_hi:[1,0,1]
    v_pk_fma_f32 v[166:167], v[166:167], v[10:11], v[8:9] op_sel:[0,0,1] op_sel_hi:[1,0,1]
    v_pk_fma_f32 v[168:169], v[168:169], v[10:11], v[8:9] op_sel:[0,0,1] op_sel_hi:[1,0,1]
    v_pk_fma_f32 v[170:171], v[170:171], v[10:11], v[8:9] op_sel:[0,0,1] op_sel_hi:[1,0,1]
    v_pk_mul_f32 v[164:165], v[164:165], v[96:97]
    v_pk_mul_f32 v[166:167], v[166:167], v[98:99]
    v_pk_mul_f32 v[168:169], v[168:169], v[100:101]
    v_pk_mul_f32 v[170:171], v[170:171], v[102:103]
    v_exp_f32 v164, v164
    v_exp_f32 v165, v165
    v_exp_f32 v166, v166
    v_exp_f32 v167, v167
    v_exp_f32 v168, v168
    v_exp_f32 v169, v169
    v_exp_f32 v170, v170
    v_exp_f32 v171, v171
    v_pk_mul_f32 v[96:97], v[96:97], v[112:113]
    v_pk_mul_f32 v[98:99], v[98:99], v[114:115]
    v_pk_mul_f32 v[100:101], v[100:101], v[116:117]
    v_pk_mul_f32 v[102:103], v[102:103], v[118:119]
    v_pk_fma_f32 v[164:165], v[164:165], v[10:11], v[10:11] op_sel:[0,1,1] op_sel_hi:[1,1,1]
    v_pk_fma_f32 v[166:167], v[166:167], v[10:11], v[10:11] op_sel:[0,1,1] op_sel_hi:[1,1,1]
    v_pk_fma_f32 v[168:169], v[168:169], v[10:11], v[10:11] op_sel:[0,1,1] op_sel_hi:[1,1,1]
    v_pk_fma_f32 v[170:171], v[170:171], v[10:11], v[10:11] op_sel:[0,1,1] op_sel_hi:[1,1,1]
    v_rcp_f32 v164, v164
    v_rcp_f32 v165, v165
    v_rcp_f32 v166, v166
    v_rcp_f32 v167, v167
    v_rcp_f32 v168, v168
    v_rcp_f32 v169, v169
    v_rcp_f32 v170, v170
    v_rcp_f32 v171, v171
    v_pk_mul_f32 v[96:97], v[96:97], v[164:165]
    v_pk_mul_f32 v[98:99], v[98:99], v[166:167]
    v_pk_mul_f32 v[100:101], v[100:101], v[168:169]
    v_pk_mul_f32 v[102:103], v[102:103], v[170:171]
    v_cvt_pk_bf16_f32 v172, v96, v97
    v_cvt_pk_bf16_f32 v173, v98, v99
    v_cvt_pk_bf16_f32 v174, v100, v101
    v_cvt_pk_bf16_f32 v175, v102, v103
    buffer_store_dwordx4 v[172:175], v24, s[12:15], 0 offen offset:0 sc1
    s_waitcnt vmcnt(6)
    buffer_atomic_add v2, v8, s[12:15], s82 offen
    s_addk_i32 s82, 2048
    v_pk_mul_f32 v[164:165], v[104:105], v[104:105]
    v_pk_mul_f32 v[166:167], v[106:107], v[106:107]
    v_pk_mul_f32 v[168:169], v[108:109], v[108:109]
    v_pk_mul_f32 v[170:171], v[110:111], v[110:111]
    v_pk_fma_f32 v[164:165], v[164:165], v[10:11], v[8:9] op_sel:[0,0,1] op_sel_hi:[1,0,1]
    v_pk_fma_f32 v[166:167], v[166:167], v[10:11], v[8:9] op_sel:[0,0,1] op_sel_hi:[1,0,1]
    v_pk_fma_f32 v[168:169], v[168:169], v[10:11], v[8:9] op_sel:[0,0,1] op_sel_hi:[1,0,1]
    v_pk_fma_f32 v[170:171], v[170:171], v[10:11], v[8:9] op_sel:[0,0,1] op_sel_hi:[1,0,1]
    v_pk_mul_f32 v[164:165], v[164:165], v[104:105]
    v_pk_mul_f32 v[166:167], v[166:167], v[106:107]
    v_pk_mul_f32 v[168:169], v[168:169], v[108:109]
    v_pk_mul_f32 v[170:171], v[170:171], v[110:111]
    v_exp_f32 v164, v164
    v_exp_f32 v165, v165
    v_exp_f32 v166, v166
    v_exp_f32 v167, v167
    v_exp_f32 v168, v168
    v_exp_f32 v169, v169
    v_exp_f32 v170, v170
    v_exp_f32 v171, v171
    v_pk_mul_f32 v[104:105], v[104:105], v[120:121]
    v_pk_mul_f32 v[106:107], v[106:107], v[122:123]
    v_pk_mul_f32 v[108:109], v[108:109], v[124:125]
    v_pk_mul_f32 v[110:111], v[110:111], v[126:127]
    v_pk_fma_f32 v[164:165], v[164:165], v[10:11], v[10:11] op_sel:[0,1,1] op_sel_hi:[1,1,1]
    v_pk_fma_f32 v[166:167], v[166:167], v[10:11], v[10:11] op_sel:[0,1,1] op_sel_hi:[1,1,1]
    v_pk_fma_f32 v[168:169], v[168:169], v[10:11], v[10:11] op_sel:[0,1,1] op_sel_hi:[1,1,1]
    v_pk_fma_f32 v[170:171], v[170:171], v[10:11], v[10:11] op_sel:[0,1,1] op_sel_hi:[1,1,1]
    v_rcp_f32 v164, v164
    v_rcp_f32 v165, v165
    v_rcp_f32 v166, v166
    v_rcp_f32 v167, v167
    v_rcp_f32 v168, v168
    v_rcp_f32 v169, v169
    v_rcp_f32 v170, v170
    v_rcp_f32 v171, v171
    v_pk_mul_f32 v[104:105], v[104:105], v[164:165]
    v_pk_mul_f32 v[106:107], v[106:107], v[166:167]
    v_pk_mul_f32 v[108:109], v[108:109], v[168:169]
    v_pk_mul_f32 v[110:111], v[110:111], v[170:171]
    v_cvt_pk_bf16_f32 v172, v104, v105
    v_cvt_pk_bf16_f32 v173, v106, v107
    v_cvt_pk_bf16_f32 v174, v108, v109
    v_cvt_pk_bf16_f32 v175, v110, v111
    buffer_store_dwordx4 v[172:175], v24, s[12:15], 0 offen offset:512 sc1
    s_waitcnt vmcnt(6)
    v_cmp_eq_u32 vcc, s47, v7
    s_cbranch_vccz L_slow_19x
L_pdone_20:
    s_addk_i32 s42, 2048
    v_mfma_f32_16x16x32_bf16 a[224:227], v[188:191], a[32:35], 0
    buffer_load_dwordx4 v[64:67], v44, s[12:15], 0 offen sc1
    v_mfma_f32_16x16x32_bf16 a[228:231], v[192:195], a[32:35], 0
    ds_read_b128 a[160:163], v29 offset:0
    v_mfma_f32_16x16x32_bf16 a[232:235], v[196:199], a[32:35], 0
    v_mfma_f32_16x16x32_bf16 a[236:239], v[200:203], a[32:35], 0
    ds_read_b128 a[164:167], v29 offset:1024
    v_mfma_f32_16x16x32_bf16 a[224:227], v[204:207], a[36:39], a[224:227]
    buffer_load_dwordx4 v[68:71], v44, s[12:15], 0 offen offset:1024 sc1
    v_mfma_f32_16x16x32_bf16 a[228:231], v[208:211], a[36:39], a[228:231]
    ds_read_b128 a[168:171], v29 offset:2048
    v_mfma_f32_16x16x32_bf16 a[232:235], v[212:215], a[36:39], a[232:235]
    v_mfma_f32_16x16x32_bf16 a[236:239], v[216:219], a[36:39], a[236:239]
    ds_read_b128 a[172:175], v29 offset:3072
    v_mfma_f32_16x16x32_bf16 a[224:227], v[220:223], a[40:43], a[224:227]
    buffer_load_dwordx4 v[72:75], v44, s[12:15], 0 offen offset:2048 sc1
    v_mfma_f32_16x16x32_bf16 a[228:231], v[224:227], a[40:43], a[228:231]
    ds_read_b128 a[176:179], v29 offset:4096
    v_mfma_f32_16x16x32_bf16 a[232:235], v[228:231], a[40:43], a[232:235]
    v_mfma_f32_16x16x32_bf16 a[236:239], v[232:235], a[40:43], a[236:239]
    ds_read_b128 a[180:183], v29 offset:5120
    v_mfma_f32_16x16x32_bf16 a[224:227], v[236:239], a[44:47], a[224:227]
    buffer_load_dwordx4 v[76:79], v44, s[12:15], 0 offen offset:3072 sc1
    v_mfma_f32_16x16x32_bf16 a[228:231], v[240:243], a[44:47], a[228:231]
    ds_read_b128 a[184:187], v29 offset:6144
    v_mfma_f32_16x16x32_bf16 a[232:235], v[244:247], a[44:47], a[232:235]
    v_mov_b32_e64 v7, 0
    buffer_atomic_add v7, v252, s[12:15], s42 offen sc0
    v_mfma_f32_16x16x32_bf16 a[236:239], v[248:251], a[44:47], a[236:239]
    ds_read_b128 a[188:191], v29 offset:7168
    v_mfma_f32_16x16x32_bf16 a[224:227], a[240:243], a[48:51], a[224:227]
    buffer_load_dwordx4 v[80:83], v44, s[12:15], s38 offen offset:2048 sc1
    v_mfma_f32_16x16x32_bf16 a[228:231], a[244:247], a[48:51], a[228:231]
    ds_read_b128 a[192:195], v29 offset:8192
    v_mfma_f32_16x16x32_bf16 a[232:235], a[248:251], a[48:51], a[232:235]
    v_mfma_f32_16x16x32_bf16 a[236:239], a[252:255], a[48:51], a[236:239]
    ds_read_b128 a[196:199], v29 offset:9216
    v_mfma_f32_16x16x32_bf16 a[224:227], v[176:179], a[52:55], a[224:227]
    buffer_load_dwordx4 v[84:87], v44, s[12:15], s38 offen offset:3072 sc1
    v_mfma_f32_16x16x32_bf16 a[228:231], v[180:183], a[52:55], a[228:231]
    ds_read_b128 a[200:203], v29 offset:10240
    v_mfma_f32_16x16x32_bf16 a[232:235], v[184:187], a[52:55], a[232:235]
    v_mfma_f32_16x16x32_bf16 a[236:239], v[56:59], a[52:55], a[236:239]
    ds_read_b128 a[204:207], v29 offset:11264
    v_mfma_f32_16x16x32_bf16 a[224:227], a[0:3], a[56:59], a[224:227]
    buffer_load_dwordx4 v[88:91], v44, s[12:15], s39 offen sc1
    v_mfma_f32_16x16x32_bf16 a[228:231], a[4:7], a[56:59], a[228:231]
    ds_read_b128 a[208:211], v29 offset:12288
    v_mfma_f32_16x16x32_bf16 a[232:235], a[8:11], a[56:59], a[232:235]
    v_mfma_f32_16x16x32_bf16 a[236:239], a[12:15], a[56:59], a[236:239]
    ds_read_b128 a[212:215], v29 offset:13312
    v_mfma_f32_16x16x32_bf16 a[224:227], a[16:19], a[60:63], a[224:227]
    buffer_load_dwordx4 v[92:95], v44, s[12:15], s39 offen offset:1024 sc1
    v_mfma_f32_16x16x32_bf16 a[228:231], a[20:23], a[60:63], a[228:231]
    ds_read_b128 a[216:219], v29 offset:14336
    v_mfma_f32_16x16x32_bf16 a[232:235], a[24:27], a[60:63], a[232:235]
    v_mfma_f32_16x16x32_bf16 a[236:239], a[28:31], a[60:63], a[236:239]
    ds_read_b128 a[220:223], v29 offset:15360
    s_waitcnt lgkmcnt(14)
    v_mfma_f32_16x16x32_bf16 a[224:227], a[128:131], a[64:67], a[224:227]
    buffer_load_dwordx4 v[128:131], v44, s[12:15], s37 offen sc1
    v_mfma_f32_16x16x32_bf16 a[228:231], a[132:135], a[64:67], a[228:231]
    v_mfma_f32_16x16x32_bf16 a[232:235], a[136:139], a[64:67], a[232:235]
    v_mov_b32 v23, 0
    buffer_atomic_add v23, v252, s[12:15], s42 offen sc0
    v_mfma_f32_16x16x32_bf16 a[236:239], a[140:143], a[64:67], a[236:239]
    v_mfma_f32_16x16x32_bf16 a[224:227], a[144:147], a[68:71], a[224:227]
    buffer_load_dwordx4 v[132:135], v44, s[12:15], s37 offen offset:1024 sc1
    s_waitcnt vmcnt(12)
    buffer_atomic_add v2, v8, s[12:15], s82 offen
    s_addk_i32 s82, 2048
    v_mfma_f32_16x16x32_bf16 a[228:231], a[148:151], a[68:71], a[228:231]
    v_mfma_f32_16x16x32_bf16 a[232:235], a[152:155], a[68:71], a[232:235]
    v_mfma_f32_16x16x32_bf16 a[236:239], a[156:159], a[68:71], a[236:239]
    v_mfma_f32_16x16x32_bf16 a[224:227], a[160:163], a[72:75], a[224:227]
    buffer_load_dwordx4 v[136:139], v44, s[12:15], s37 offen offset:2048 sc1
    v_mfma_f32_16x16x32_bf16 a[228:231], a[164:167], a[72:75], a[228:231]
    s_waitcnt lgkmcnt(13)
    v_mfma_f32_16x16x32_bf16 a[232:235], a[168:171], a[72:75], a[232:235]
    s_waitcnt lgkmcnt(12)
    v_mfma_f32_16x16x32_bf16 a[236:239], a[172:175], a[72:75], a[236:239]
    s_waitcnt lgkmcnt(11)
    v_mfma_f32_16x16x32_bf16 a[224:227], a[176:179], a[76:79], a[224:227]
    buffer_load_dwordx4 v[140:143], v44, s[12:15], s37 offen offset:3072 sc1
    s_waitcnt lgkmcnt(10)
    v_mfma_f32_16x16x32_bf16 a[228:231], a[180:183], a[76:79], a[228:231]
    s_waitcnt lgkmcnt(9)
    v_mfma_f32_16x16x32_bf16 a[232:235], a[184:187], a[76:79], a[232:235]
    s_waitcnt lgkmcnt(8)
    v_mfma_f32_16x16x32_bf16 a[236:239], a[188:191], a[76:79], a[236:239]
    s_waitcnt lgkmcnt(7)
    v_mfma_f32_16x16x32_bf16 a[224:227], a[192:195], a[80:83], a[224:227]
    buffer_load_dwordx4 v[144:147], v44, s[12:15], s38 offen sc1
    s_waitcnt lgkmcnt(6)
    v_mfma_f32_16x16x32_bf16 a[228:231], a[196:199], a[80:83], a[228:231]
    s_waitcnt lgkmcnt(5)
    v_mfma_f32_16x16x32_bf16 a[232:235], a[200:203], a[80:83], a[232:235]
    s_waitcnt lgkmcnt(4)
    v_mfma_f32_16x16x32_bf16 a[236:239], a[204:207], a[80:83], a[236:239]
    s_waitcnt lgkmcnt(3)
    v_mfma_f32_16x16x32_bf16 a[224:227], a[208:211], a[84:87], a[224:227]
    buffer_load_dwordx4 v[148:151], v44, s[12:15], s38 offen offset:1024 sc1
    v_add_u32 v44, 114688, v44
    s_barrier
    s_waitcnt lgkmcnt(2)
    v_mfma_f32_16x16x32_bf16 a[228:231], a[212:215], a[84:87], a[228:231]
    s_waitcnt lgkmcnt(1)
    v_mfma_f32_16x16x32_bf16 a[232:235], a[216:219], a[84:87], a[232:235]
    s_waitcnt lgkmcnt(0)
    v_mfma_f32_16x16x32_bf16 a[236:239], a[220:223], a[84:87], a[236:239]
    s_waitcnt vmcnt(16)
    v_mfma_f32_16x16x32_bf16 a[96:99], v[188:191], v[64:67], 0
    s_waitcnt vmcnt(12)
    v_cmp_eq_u32 vcc, s47, v7
    s_cbranch_vccz L_slow_21x
L_pdone_22:
    s_addk_i32 s42, 2048
    v_mfma_f32_16x16x32_bf16 a[100:103], v[192:195], v[64:67], 0
    buffer_load_dwordx4 v[96:99], v44, s[12:15], 0 offen sc1
    v_mfma_f32_16x16x32_bf16 a[104:107], v[196:199], v[64:67], 0
    v_mfma_f32_16x16x32_bf16 a[108:111], v[200:203], v[64:67], 0
    v_mfma_f32_16x16x32_bf16 a[96:99], v[204:207], v[68:71], a[96:99]
    v_mfma_f32_16x16x32_bf16 a[100:103], v[208:211], v[68:71], a[100:103]
    buffer_load_dwordx4 v[100:103], v44, s[12:15], 0 offen offset:1024 sc1
    v_mfma_f32_16x16x32_bf16 a[104:107], v[212:215], v[68:71], a[104:107]
    ds_write_b128 v42, a[224:227] offset:0
    v_mfma_f32_16x16x32_bf16 a[108:111], v[216:219], v[68:71], a[108:111]
    v_mfma_f32_16x16x32_bf16 a[96:99], v[220:223], v[72:75], a[96:99]
    v_mfma_f32_16x16x32_bf16 a[100:103], v[224:227], v[72:75], a[100:103]
    buffer_load_dwordx4 v[104:107], v44, s[12:15], 0 offen offset:2048 sc1
    v_mfma_f32_16x16x32_bf16 a[104:107], v[228:231], v[72:75], a[104:107]
    ds_write_b128 v42, a[228:231] offset:1152
    v_mfma_f32_16x16x32_bf16 a[108:111], v[232:235], v[72:75], a[108:111]
    v_mfma_f32_16x16x32_bf16 a[96:99], v[236:239], v[76:79], a[96:99]
    v_mfma_f32_16x16x32_bf16 a[100:103], v[240:243], v[76:79], a[100:103]
    buffer_load_dwordx4 v[108:111], v44, s[12:15], 0 offen offset:3072 sc1
    v_mfma_f32_16x16x32_bf16 a[104:107], v[244:247], v[76:79], a[104:107]
    ds_write_b128 v42, a[232:235] offset:2304
    v_mfma_f32_16x16x32_bf16 a[108:111], v[248:251], v[76:79], a[108:111]
    s_waitcnt vmcnt(15)
    v_mfma_f32_16x16x32_bf16 a[96:99], a[240:243], v[80:83], a[96:99]
    v_mfma_f32_16x16x32_bf16 a[100:103], a[244:247], v[80:83], a[100:103]
    buffer_load_dwordx4 v[112:115], v44, s[12:15], s38 offen offset:2048 sc1
    v_mfma_f32_16x16x32_bf16 a[104:107], a[248:251], v[80:83], a[104:107]
    ds_write_b128 v42, a[236:239] offset:3456
    v_mov_b32 v7, 0
    buffer_atomic_add v7, v252, s[12:15], s42 offen sc0
    v_mfma_f32_16x16x32_bf16 a[108:111], a[252:255], v[80:83], a[108:111]
    s_waitcnt vmcnt(16)
    v_mfma_f32_16x16x32_bf16 a[96:99], v[176:179], v[84:87], a[96:99]
    v_mfma_f32_16x16x32_bf16 a[100:103], v[180:183], v[84:87], a[100:103]
    buffer_load_dwordx4 v[116:119], v44, s[12:15], s38 offen offset:3072 sc1
    v_mfma_f32_16x16x32_bf16 a[104:107], v[184:187], v[84:87], a[104:107]
    v_mfma_f32_16x16x32_bf16 a[108:111], v[56:59], v[84:87], a[108:111]
    s_waitcnt vmcnt(16)
    v_mfma_f32_16x16x32_bf16 a[96:99], a[0:3], v[88:91], a[96:99]
    v_mfma_f32_16x16x32_bf16 a[100:103], a[4:7], v[88:91], a[100:103]
    buffer_load_dwordx4 v[120:123], v44, s[12:15], s39 offen sc1
    v_mfma_f32_16x16x32_bf16 a[104:107], a[8:11], v[88:91], a[104:107]
    s_waitcnt lgkmcnt(0)
    s_barrier
    v_mfma_f32_16x16x32_bf16 a[108:111], a[12:15], v[88:91], a[108:111]
    ds_read_b128 v[28:31], v41 offset:0
    s_waitcnt vmcnt(16)
    v_mfma_f32_16x16x32_bf16 a[96:99], a[16:19], v[92:95], a[96:99]
    ds_read_b128 v[32:35], v41 offset:4608
    v_mfma_f32_16x16x32_bf16 a[100:103], a[20:23], v[92:95], a[100:103]
    ds_read_b128 v[36:39], v41 offset:9216
    buffer_load_dwordx4 v[124:127], v44, s[12:15], s39 offen offset:1024 sc1
    v_mfma_f32_16x16x32_bf16 a[104:107], a[24:27], v[92:95], a[104:107]
    ds_read_b128 v[12:15], v41 offset:13824
    v_mfma_f32_16x16x32_bf16 a[108:111], a[28:31], v[92:95], a[108:111]
    s_waitcnt vmcnt(16)
    v_mfma_f32_16x16x32_bf16 a[96:99], a[128:131], v[128:131], a[96:99]
    v_mfma_f32_16x16x32_bf16 a[100:103], a[132:135], v[128:131], a[100:103]
    buffer_load_dwordx4 v[152:155], v44, s[12:15], s37 offen sc1
    v_mfma_f32_16x16x32_bf16 a[104:107], a[136:139], v[128:131], a[104:107]
    v_mfma_f32_16x16x32_bf16 a[108:111], a[140:143], v[128:131], a[108:111]
    s_waitcnt vmcnt(15)
    v_mfma_f32_16x16x32_bf16 a[96:99], a[144:147], v[132:135], a[96:99]
    v_mov_b32 v23, 0
    buffer_atomic_add v23, v252, s[12:15], s42 offen sc0
L_pad5:
    s_cbranch_execz L_walk_back
    v_lshlrev_b32 v16, 16, v46
    v_and_b32 v17, 0xffff0000, v46
    v_mfma_f32_16x16x32_bf16 a[100:103], a[148:151], v[132:135], a[100:103]
    buffer_load_dwordx4 v[156:159], v44, s[12:15], s37 offen offset:1024 sc1
    v_lshlrev_b32_e64 v18, 16, v47
    v_and_b32 v19, 0xffff0000, v47
    v_mfma_f32_16x16x32_bf16 a[104:107], a[152:155], v[132:135], a[104:107]
    s_waitcnt lgkmcnt(2)
    v_add_f32 v28, v28, v32
    v_add_f32_e64 v29, v29, v33
    v_mfma_f32_16x16x32_bf16 a[108:111], a[156:159], v[132:135], a[108:111]
    v_add_f32_e64 v30, v30, v34
    v_add_f32 v31, v31, v35
    s_waitcnt vmcnt(15)
    v_mfma_f32_16x16x32_bf16 a[96:99], a[160:163], v[136:139], a[96:99]
    s_waitcnt lgkmcnt(0)
    v_add_f32 v36, v36, v12
    v_add_f32_e64 v37, v37, v13
    v_mfma_f32_16x16x32_bf16 a[100:103], a[164:167], v[136:139], a[100:103]
    buffer_load_dwordx4 v[160:163], v44, s[12:15], s37 offen offset:2048 sc1
    v_add_f32 v38, v38, v14
    v_add_f32 v39, v39, v15
    v_mfma_f32_16x16x32_bf16 a[104:107], a[168:171], v[136:139], a[104:107]
    v_add_f32 v28, v28, v16
    v_add_f32 v29, v29, v17
    v_mfma_f32_16x16x32_bf16 a[108:111], a[172:175], v[136:139], a[108:111]
    v_add_f32_e64 v30, v30, v18
    v_add_f32 v31, v31, v19
    s_waitcnt vmcnt(15)
    v_mfma_f32_16x16x32_bf16 a[96:99], a[176:179], v[140:143], a[96:99]
    v_add_f32 v28, v28, v36
    v_add_f32 v29, v29, v37
    v_mfma_f32_16x16x32_bf16 a[100:103], a[180:183], v[140:143], a[100:103]
    buffer_load_dwordx4 v[164:167], v44, s[12:15], s37 offen offset:3072 sc1
    v_add_f32 v30, v30, v38
    v_add_f32 v31, v31, v39
    v_mfma_f32_16x16x32_bf16 a[104:107], a[184:187], v[140:143], a[104:107]
    v_cvt_pk_bf16_f32 v20, v28, v29
    v_cvt_pk_bf16_f32 v21, v30, v31
    v_mfma_f32_16x16x32_bf16 a[108:111], a[188:191], v[140:143], a[108:111]
    s_mov_b32 s5, 0
    s_waitcnt vmcnt(15)
    v_mfma_f32_16x16x32_bf16 a[96:99], a[192:195], v[144:147], a[96:99]
    buffer_store_dwordx2 v[20:21], v45, s[28:31], s5 offen
    v_mfma_f32_16x16x32_bf16 a[100:103], a[196:199], v[144:147], a[100:103]
    buffer_load_dwordx4 v[168:171], v44, s[12:15], s38 offen sc1
    v_mfma_f32_16x16x32_bf16 a[104:107], a[200:203], v[144:147], a[104:107]
    v_mfma_f32_16x16x32_bf16 a[108:111], a[204:207], v[144:147], a[108:111]
    s_waitcnt vmcnt(16)
    v_mfma_f32_16x16x32_bf16 a[96:99], a[208:211], v[148:151], a[96:99]
    v_mfma_f32_16x16x32_bf16 a[100:103], a[212:215], v[148:151], a[100:103]
    buffer_load_dwordx4 v[172:175], v44, s[12:15], s38 offen offset:1024 sc1
    v_add_u32 v44, 114688, v44
    v_mfma_f32_16x16x32_bf16 a[104:107], a[216:219], v[148:151], a[104:107]
    v_mfma_f32_16x16x32_bf16 a[108:111], a[220:223], v[148:151], a[108:111]
    s_waitcnt vmcnt(11)
    v_cmp_eq_u32 vcc, s47, v7
    s_cbranch_vccz L_slow_23x
L_pdone_24:
    v_mfma_f32_16x16x32_bf16 a[224:227], v[188:191], v[96:99], 0
    buffer_load_dwordx4 a[32:35], v44, s[12:15], 0 offen sc1
    v_mfma_f32_16x16x32_bf16 a[228:231], v[192:195], v[96:99], 0
    v_mfma_f32_16x16x32_bf16 a[232:235], v[196:199], v[96:99], 0
    v_mfma_f32_16x16x32_bf16 a[236:239], v[200:203], v[96:99], 0
    v_mfma_f32_16x16x32_bf16 a[224:227], v[204:207], v[100:103], a[224:227]
    buffer_load_dwordx4 a[36:39], v44, s[12:15], 0 offen offset:1024 sc1
    v_mfma_f32_16x16x32_bf16 a[228:231], v[208:211], v[100:103], a[228:231]
    v_mfma_f32_16x16x32_bf16 a[232:235], v[212:215], v[100:103], a[232:235]
    ds_write_b128 v42, a[96:99] offset:18432
    v_mfma_f32_16x16x32_bf16 a[236:239], v[216:219], v[100:103], a[236:239]
    v_mfma_f32_16x16x32_bf16 a[224:227], v[220:223], v[104:107], a[224:227]
    buffer_load_dwordx4 a[40:43], v44, s[12:15], 0 offen offset:2048 sc1
    v_mfma_f32_16x16x32_bf16 a[228:231], v[224:227], v[104:107], a[228:231]
    v_mfma_f32_16x16x32_bf16 a[232:235], v[228:231], v[104:107], a[232:235]
    ds_write_b128 v42, a[100:103] offset:19584
    v_mfma_f32_16x16x32_bf16 a[236:239], v[232:235], v[104:107], a[236:239]
    v_mfma_f32_16x16x32_bf16 a[224:227], v[236:239], v[108:111], a[224:227]
    buffer_load_dwordx4 a[44:47], v44, s[12:15], 0 offen offset:3072 sc1
    v_mfma_f32_16x16x32_bf16 a[228:231], v[240:243], v[108:111], a[228:231]
    v_mfma_f32_16x16x32_bf16 a[232:235], v[244:247], v[108:111], a[232:235]
    ds_write_b128 v42, a[104:107] offset:20736
    v_mfma_f32_16x16x32_bf16 a[236:239], v[248:251], v[108:111], a[236:239]
    v_mfma_f32_16x16x32_bf16 a[224:227], a[240:243], v[112:115], a[224:227]
    buffer_load_dwordx4 a[48:51], v44, s[12:15], s38 offen offset:2048 sc1
    v_mfma_f32_16x16x32_bf16 a[228:231], a[244:247], v[112:115], a[228:231]
    v_mfma_f32_16x16x32_bf16 a[232:235], a[248:251], v[112:115], a[232:235]
    ds_write_b128 v42, a[108:111] offset:21888
    v_mfma_f32_16x16x32_bf16 a[236:239], a[252:255], v[112:115], a[236:239]
    s_waitcnt vmcnt(15)
    v_mfma_f32_16x16x32_bf16 a[224:227], v[176:179], v[116:119], a[224:227]
    buffer_load_dwordx4 a[52:55], v44, s[12:15], s38 offen offset:3072 sc1
    v_mfma_f32_16x16x32_bf16 a[228:231], v[180:183], v[116:119], a[228:231]
    v_mfma_f32_16x16x32_bf16 a[232:235], v[184:187], v[116:119], a[232:235]
    v_mfma_f32_16x16x32_bf16 a[236:239], v[56:59], v[116:119], a[236:239]
    s_waitcnt vmcnt(15)
    v_mfma_f32_16x16x32_bf16 a[224:227], a[0:3], v[120:123], a[224:227]
    buffer_load_dwordx4 a[56:59], v44, s[12:15], s39 offen sc1
    v_mfma_f32_16x16x32_bf16 a[228:231], a[4:7], v[120:123], a[228:231]
    v_mfma_f32_16x16x32_bf16 a[232:235], a[8:11], v[120:123], a[232:235]
    s_waitcnt lgkmcnt(0)
    s_barrier
    v_mfma_f32_16x16x32_bf16 a[236:239], a[12:15], v[120:123], a[236:239]
    ds_read_b128 v[28:31], v41 offset:18432
    s_waitcnt vmcnt(15)
    v_mfma_f32_16x16x32_bf16 a[224:227], a[16:19], v[124:127], a[224:227]
    ds_read_b128 v[32:35], v41 offset:23040
    buffer_load_dwordx4 a[60:63], v44, s[12:15], s39 offen offset:1024 sc1
    v_mfma_f32_16x16x32_bf16 a[228:231], a[20:23], v[124:127], a[228:231]
    ds_read_b128 v[36:39], v41 offset:27648
    v_mfma_f32_16x16x32_bf16 a[232:235], a[24:27], v[124:127], a[232:235]
    ds_read_b128 v[12:15], v41 offset:32256
    v_mfma_f32_16x16x32_bf16 a[236:239], a[28:31], v[124:127], a[236:239]
    s_waitcnt vmcnt(15)
    v_mfma_f32_16x16x32_bf16 a[224:227], a[128:131], v[152:155], a[224:227]
    buffer_load_dwordx4 a[64:67], v44, s[12:15], s37 offen sc1
    v_mfma_f32_16x16x32_bf16 a[228:231], a[132:135], v[152:155], a[228:231]
    v_mfma_f32_16x16x32_bf16 a[232:235], a[136:139], v[152:155], a[232:235]
    v_mfma_f32_16x16x32_bf16 a[236:239], a[140:143], v[152:155], a[236:239]
    s_waitcnt vmcnt(14)
    v_mfma_f32_16x16x32_bf16 a[224:227], a[144:147], v[156:159], a[224:227]
    buffer_load_dwordx4 a[68:71], v44, s[12:15], s37 offen offset:1024 sc1
    v_lshlrev_b32 v16, 16, v48
    v_and_b32 v17, 0xffff0000, v48
    v_mfma_f32_16x16x32_bf16 a[228:231], a[148:151], v[156:159], a[228:231]
    v_lshlrev_b32_e64 v18, 16, v49
    v_and_b32 v19, 0xffff0000, v49
    v_mfma_f32_16x16x32_bf16 a[232:235], a[152:155], v[156:159], a[232:235]
    s_waitcnt lgkmcnt(2)
    v_add_f32 v28, v28, v32
    v_add_f32_e64 v29, v29, v33
    v_mfma_f32_16x16x32_bf16 a[236:239], a[156:159], v[156:159], a[236:239]
    v_add_f32_e64 v30, v30, v34
    v_add_f32 v31, v31, v35
    s_waitcnt vmcnt(14)
    v_mfma_f32_16x16x32_bf16 a[224:227], a[160:163], v[160:163], a[224:227]
    buffer_load_dwordx4 a[72:75], v44, s[12:15], s37 offen offset:2048 sc1
    s_waitcnt lgkmcnt(0)
    v_add_f32 v36, v36, v12
    v_add_f32_e64 v37, v37, v13
    v_mfma_f32_16x16x32_bf16 a[228:231], a[164:167], v[160:163], a[228:231]
    v_add_f32 v38, v38, v14
    v_add_f32 v39, v39, v15
    v_mfma_f32_16x16x32_bf16 a[232:235], a[168:171], v[160:163], a[232:235]
    v_add_f32 v28, v28, v16
    v_add_f32 v29, v29, v17
    v_mfma_f32_16x16x32_bf16 a[236:239], a[172:175], v[160:163], a[236:239]
    v_add_f32_e64 v30, v30, v18
    v_add_f32 v31, v31, v19
    s_waitcnt vmcnt(14)
    v_mfma_f32_16x16x32_bf16 a[224:227], a[176:179], v[164:167], a[224:227]
    buffer_load_dwordx4 a[76:79], v44, s[12:15], s37 offen offset:3072 sc1
    v_add_f32 v28, v28, v36
    v_add_f32 v29, v29, v37
    v_mfma_f32_16x16x32_bf16 a[228:231], a[180:183], v[164:167], a[228:231]
    v_add_f32 v30, v30, v38
    v_add_f32 v31, v31, v39
    v_mfma_f32_16x16x32_bf16 a[232:235], a[184:187], v[164:167], a[232:235]
    v_cvt_pk_bf16_f32 v20, v28, v29
    v_cvt_pk_bf16_f32 v21, v30, v31
    v_mfma_f32_16x16x32_bf16 a[236:239], a[188:191], v[164:167], a[236:239]
    s_mov_b32 s5, 114688
    s_waitcnt vmcnt(13)
    v_mfma_f32_16x16x32_bf16 a[224:227], a[192:195], v[168:171], a[224:227]
    buffer_store_dwordx2 v[20:21], v45, s[28:31], s5 offen
    buffer_load_dwordx4 a[80:83], v44, s[12:15], s38 offen sc1
    v_mfma_f32_16x16x32_bf16 a[228:231], a[196:199], v[168:171], a[228:231]
    v_mfma_f32_16x16x32_bf16 a[232:235], a[200:203], v[168:171], a[232:235]
    v_mfma_f32_16x16x32_bf16 a[236:239], a[204:207], v[168:171], a[236:239]
    s_waitcnt vmcnt(14)
    v_mfma_f32_16x16x32_bf16 a[224:227], a[208:211], v[172:175], a[224:227]
    buffer_load_dwordx4 a[84:87], v44, s[12:15], s38 offen offset:1024 sc1
    v_mfma_f32_16x16x32_bf16 a[228:231], a[212:215], v[172:175], a[228:231]
    v_mfma_f32_16x16x32_bf16 a[232:235], a[216:219], v[172:175], a[232:235]
    v_mfma_f32_16x16x32_bf16 a[236:239], a[220:223], v[172:175], a[236:239]
    s_waitcnt vmcnt(14)
    v_mfma_f32_16x16x32_bf16 a[96:99], v[188:191], a[32:35], 0
    v_mfma_f32_16x16x32_bf16 a[100:103], v[192:195], a[32:35], 0
    v_mfma_f32_16x16x32_bf16 a[104:107], v[196:199], a[32:35], 0
    v_mfma_f32_16x16x32_bf16 a[108:111], v[200:203], a[32:35], 0
    s_waitcnt vmcnt(13)
    v_mfma_f32_16x16x32_bf16 a[96:99], v[204:207], a[36:39], a[96:99]
    v_mfma_f32_16x16x32_bf16 a[100:103], v[208:211], a[36:39], a[100:103]
    v_mfma_f32_16x16x32_bf16 a[104:107], v[212:215], a[36:39], a[104:107]
    ds_write_b128 v42, a[224:227] offset:0
    v_mfma_f32_16x16x32_bf16 a[108:111], v[216:219], a[36:39], a[108:111]
    s_waitcnt vmcnt(12)
    v_mfma_f32_16x16x32_bf16 a[96:99], v[220:223], a[40:43], a[96:99]
    v_mfma_f32_16x16x32_bf16 a[100:103], v[224:227], a[40:43], a[100:103]
    v_mfma_f32_16x16x32_bf16 a[104:107], v[228:231], a[40:43], a[104:107]
    ds_write_b128 v42, a[228:231] offset:1152
    v_mfma_f32_16x16x32_bf16 a[108:111], v[232:235], a[40:43], a[108:111]
    s_waitcnt vmcnt(11)
    v_mfma_f32_16x16x32_bf16 a[96:99], v[236:239], a[44:47], a[96:99]
    v_mfma_f32_16x16x32_bf16 a[100:103], v[240:243], a[44:47], a[100:103]
    v_mfma_f32_16x16x32_bf16 a[104:107], v[244:247], a[44:47], a[104:107]
    ds_write_b128 v42, a[232:235] offset:2304
    v_mfma_f32_16x16x32_bf16 a[108:111], v[248:251], a[44:47], a[108:111]
    s_waitcnt vmcnt(10)
    v_mfma_f32_16x16x32_bf16 a[96:99], a[240:243], a[48:51], a[96:99]
    v_mfma_f32_16x16x32_bf16 a[100:103], a[244:247], a[48:51], a[100:103]
    v_mfma_f32_16x16x32_bf16 a[104:107], a[248:251], a[48:51], a[104:107]
    ds_write_b128 v42, a[236:239] offset:3456
    v_mfma_f32_16x16x32_bf16 a[108:111], a[252:255], a[48:51], a[108:111]
    s_waitcnt vmcnt(9)
    v_mfma_f32_16x16x32_bf16 a[96:99], v[176:179], a[52:55], a[96:99]
    v_mfma_f32_16x16x32_bf16 a[100:103], v[180:183], a[52:55], a[100:103]
    v_mfma_f32_16x16x32_bf16 a[104:107], v[184:187], a[52:55], a[104:107]
    v_mfma_f32_16x16x32_bf16 a[108:111], v[56:59], a[52:55], a[108:111]
    s_waitcnt vmcnt(8)
    v_mfma_f32_16x16x32_bf16 a[96:99], a[0:3], a[56:59], a[96:99]
    v_mfma_f32_16x16x32_bf16 a[100:103], a[4:7], a[56:59], a[100:103]
    v_mfma_f32_16x16x32_bf16 a[104:107], a[8:11], a[56:59], a[104:107]
    s_waitcnt lgkmcnt(0)
    s_barrier
    v_mfma_f32_16x16x32_bf16 a[108:111], a[12:15], a[56:59], a[108:111]
    ds_read_b128 v[28:31], v41 offset:0
    s_waitcnt vmcnt(7)
    v_mfma_f32_16x16x32_bf16 a[96:99], a[16:19], a[60:63], a[96:99]
    ds_read_b128 v[32:35], v41 offset:4608
    v_mfma_f32_16x16x32_bf16 a[100:103], a[20:23], a[60:63], a[100:103]
    ds_read_b128 v[36:39], v41 offset:9216
    v_mfma_f32_16x16x32_bf16 a[104:107], a[24:27], a[60:63], a[104:107]
    ds_read_b128 v[12:15], v41 offset:13824
    v_mfma_f32_16x16x32_bf16 a[108:111], a[28:31], a[60:63], a[108:111]
    s_waitcnt vmcnt(6)
    v_mfma_f32_16x16x32_bf16 a[96:99], a[128:131], a[64:67], a[96:99]
    s_waitcnt vmcnt(5)
    v_mfma_f32_16x16x32_bf16 a[96:99], a[144:147], a[68:71], a[96:99]
    s_waitcnt vmcnt(4)
    v_mfma_f32_16x16x32_bf16 a[96:99], a[160:163], a[72:75], a[96:99]
    s_waitcnt vmcnt(3)
    v_mfma_f32_16x16x32_bf16 a[96:99], a[176:179], a[76:79], a[96:99]
    s_waitcnt vmcnt(1)
    v_mfma_f32_16x16x32_bf16 a[96:99], a[192:195], a[80:83], a[96:99]
    v_lshlrev_b32 v16, 16, v50
    v_and_b32 v17, 0xffff0000, v50
    s_waitcnt vmcnt(0)
    v_mfma_f32_16x16x32_bf16 a[96:99], a[208:211], a[84:87], a[96:99]
    v_lshlrev_b32 v18, 16, v51
    v_and_b32 v19, 0xffff0000, v51
    v_mfma_f32_16x16x32_bf16 a[100:103], a[132:135], a[64:67], a[100:103]
    s_waitcnt lgkmcnt(2)
    v_add_f32 v28, v28, v32
    v_add_f32_e64 v29, v29, v33
    v_mfma_f32_16x16x32_bf16 a[100:103], a[148:151], a[68:71], a[100:103]
    v_add_f32 v30, v30, v34
    v_add_f32 v31, v31, v35
    v_mfma_f32_16x16x32_bf16 a[100:103], a[164:167], a[72:75], a[100:103]
    s_waitcnt lgkmcnt(0)
    v_add_f32 v36, v36, v12
    v_add_f32_e64 v37, v37, v13
    v_mfma_f32_16x16x32_bf16 a[100:103], a[180:183], a[76:79], a[100:103]
    v_add_f32 v38, v38, v14
    v_add_f32 v39, v39, v15
    v_mfma_f32_16x16x32_bf16 a[100:103], a[196:199], a[80:83], a[100:103]
    v_add_f32 v28, v28, v16
    v_add_f32 v29, v29, v17
    v_mfma_f32_16x16x32_bf16 a[100:103], a[212:215], a[84:87], a[100:103]
    v_add_f32 v30, v30, v18
    v_add_f32 v31, v31, v19
    v_mfma_f32_16x16x32_bf16 a[104:107], a[136:139], a[64:67], a[104:107]
    v_add_f32 v28, v28, v36
    v_add_f32 v29, v29, v37
    v_mfma_f32_16x16x32_bf16 a[104:107], a[152:155], a[68:71], a[104:107]
    ds_write_b128 v42, a[96:99] offset:18432
    v_add_f32 v30, v30, v38
    v_add_f32 v31, v31, v39
    v_mfma_f32_16x16x32_bf16 a[104:107], a[168:171], a[72:75], a[104:107]
    v_cvt_pk_bf16_f32 v20, v28, v29
    v_cvt_pk_bf16_f32 v21, v30, v31
    v_mfma_f32_16x16x32_bf16 a[104:107], a[184:187], a[76:79], a[104:107]
    s_mov_b32 s5, 917504
    v_mfma_f32_16x16x32_bf16 a[104:107], a[200:203], a[80:83], a[104:107]
    buffer_store_dwordx2 v[20:21], v45, s[28:31], s5 offen
    v_mfma_f32_16x16x32_bf16 a[104:107], a[216:219], a[84:87], a[104:107]
    v_mfma_f32_16x16x32_bf16 a[108:111], a[140:143], a[64:67], a[108:111]
    v_mfma_f32_16x16x32_bf16 a[108:111], a[156:159], a[68:71], a[108:111]
    ds_write_b128 v42, a[100:103] offset:19584
    v_mfma_f32_16x16x32_bf16 a[108:111], a[172:175], a[72:75], a[108:111]
    v_mfma_f32_16x16x32_bf16 a[108:111], a[188:191], a[76:79], a[108:111]
    v_mfma_f32_16x16x32_bf16 a[108:111], a[204:207], a[80:83], a[108:111]
    v_mfma_f32_16x16x32_bf16 a[108:111], a[220:223], a[84:87], a[108:111]
    s_nop 0
    ds_write_b128 v42, a[104:107] offset:20736
    s_nop 5
    ds_write_b128 v42, a[108:111] offset:21888
    s_waitcnt lgkmcnt(0)
    s_barrier
    ds_read_b128 v[28:31], v41 offset:18432
    ds_read_b128 v[32:35], v41 offset:23040
    ds_read_b128 v[36:39], v41 offset:27648
    ds_read_b128 v[12:15], v41 offset:32256
    v_lshlrev_b32_e64 v16, 16, v52
    v_and_b32 v17, 0xffff0000, v52
    v_lshlrev_b32 v18, 16, v53
    v_and_b32 v19, 0xffff0000, v53
    s_waitcnt lgkmcnt(3)
    v_pk_add_f32 v[28:29], v[28:29], v[16:17]
    v_pk_add_f32 v[30:31], v[30:31], v[18:19]
    s_waitcnt lgkmcnt(1)
    v_pk_add_f32 v[32:33], v[32:33], v[36:37]
    v_pk_add_f32 v[34:35], v[34:35], v[38:39]
    s_waitcnt lgkmcnt(0)
    v_pk_add_f32 v[28:29], v[28:29], v[12:13]
    v_pk_add_f32 v[30:31], v[30:31], v[14:15]
    v_pk_add_f32 v[28:29], v[28:29], v[32:33]
    v_pk_add_f32 v[30:31], v[30:31], v[34:35]
    v_cvt_pk_bf16_f32 v20, v28, v29
    v_cvt_pk_bf16_f32 v21, v30, v31
    s_mov_b32 s5, 1032192
    buffer_store_dwordx2 v[20:21], v45, s[28:31], s5 offen
L_fin:
L_end:
    s_endpgm
L_slow_1x:
L_slow_1:
    s_mov_b32 s33, 0
L_slow_1_l:
    s_mov_b64 exec, vcc
    s_sleep 1
    v_mov_b32 v6, 0
    buffer_atomic_add v6, v26, s[12:15], 0 offen sc0
    s_waitcnt vmcnt(0)
    v_cmp_ne_u32 vcc, s32, v6
    s_mov_b64 exec, -1
    s_cbranch_vccz L_pdone_2
    s_add_u32 s33, s33, 1
    s_cmp_lt_u32 s33, 0x40000
    s_cbranch_scc1 L_slow_1_l
    s_branch L_pdone_2
L_slow_3:
    s_mov_b32 s33, 0
L_slow_3_l:
    s_mov_b64 exec, vcc
    s_sleep 1
    v_mov_b32 v7, 0
    buffer_atomic_add v7, v43, s[12:15], s40 offen sc0
    s_waitcnt vmcnt(0)
    v_cmp_ne_u32 vcc, s46, v7
    s_mov_b64 exec, -1
    s_cbranch_vccz L_pdone_4
    s_add_u32 s33, s33, 1
    s_cmp_lt_u32 s33, 0x40000
    s_cbranch_scc1 L_slow_3_l
    s_branch L_pdone_4
L_slow_5x:
    s_mov_b64 vcc, 1
L_slow_5:
    s_mov_b32 s33, 0
L_slow_5_l:
    s_mov_b64 exec, vcc
    s_sleep 1
    v_mov_b32 v25, 0
    buffer_atomic_add v25, v252, s[12:15], s41 offen sc0
    s_waitcnt vmcnt(0)
    v_cmp_ne_u32 vcc, s46, v25
    s_mov_b64 exec, -1
    s_cbranch_vccz L_pdone_6
    s_add_u32 s33, s33, 1
    s_cmp_lt_u32 s33, 0x40000
    s_cbranch_scc1 L_slow_5_l
    s_branch L_pdone_6
L_sslow_7:
    s_mov_b32 s33, 0
L_sslow_7_l:
    s_mov_b64 exec, vcc
    s_sleep 1
    v_mov_b64 v[60:61], 0
    buffer_atomic_add_x2 v[60:61], v22, s[12:15], 0 offen offset:0 sc0
    s_waitcnt vmcnt(0)
    v_cmp_ne_u32 vcc, s32, v61
    s_mov_b64 exec, -1
    s_cbranch_vccz L_sdone_8
    s_add_u32 s33, s33, 1
    s_cmp_lt_u32 s33, 0x40000
    s_cbranch_scc1 L_sslow_7_l
    s_branch L_sdone_8
L_slow_9x:
    s_waitcnt vmcnt(7)
    v_cmp_ne_u32 vcc, s46, v25
    s_and_b64 vcc, vcc, 3
    s_cbranch_scc0 L_pdone_10
L_slow_9:
    s_mov_b32 s33, 0
L_slow_9_l:
    s_mov_b64 exec, vcc
    s_sleep 1
    v_mov_b32 v23, 0
    buffer_atomic_add v23, v43, s[12:15], s40 offen sc0
    s_waitcnt vmcnt(0)
    v_cmp_ne_u32 vcc, s46, v23
    s_mov_b64 exec, -1
    s_cbranch_vccz L_pdone_10
    s_add_u32 s33, s33, 1
    s_cmp_lt_u32 s33, 0x40000
    s_cbranch_scc1 L_slow_9_l
    s_branch L_pdone_10
L_sslow_11:
    s_mov_b32 s33, 0
L_sslow_11_l:
    s_mov_b64 exec, vcc
    s_sleep 1
    v_mov_b64 v[62:63], 0
    buffer_atomic_add_x2 v[62:63], v22, s[12:15], 0 offen offset:256 sc0
    s_waitcnt vmcnt(0)
    v_cmp_ne_u32 vcc, s32, v63
    s_mov_b64 exec, -1
    s_cbranch_vccz L_sdone_12
    s_add_u32 s33, s33, 1
    s_cmp_lt_u32 s33, 0x40000
    s_cbranch_scc1 L_sslow_11_l
    s_branch L_sdone_12
L_sslow_13:
    s_mov_b32 s33, 0
L_sslow_13_l:
    s_mov_b64 exec, vcc
    s_sleep 1
    v_mov_b64 v[60:61], 0
    buffer_atomic_add_x2 v[60:61], v22, s[12:15], 0 offen offset:512 sc0
    s_waitcnt vmcnt(0)
    v_cmp_ne_u32 vcc, s32, v61
    s_mov_b64 exec, -1
    s_cbranch_vccz L_sdone_14
    s_add_u32 s33, s33, 1
    s_cmp_lt_u32 s33, 0x40000
    s_cbranch_scc1 L_sslow_13_l
    s_branch L_sdone_14
L_sslow_15:
    s_mov_b32 s33, 0
L_sslow_15_l:
    s_mov_b64 exec, vcc
    s_sleep 1
    v_mov_b64 v[62:63], 0
    buffer_atomic_add_x2 v[62:63], v22, s[12:15], 0 offen offset:768 sc0
    s_waitcnt vmcnt(0)
    v_cmp_ne_u32 vcc, s32, v63
    s_mov_b64 exec, -1
    s_cbranch_vccz L_sdone_16
    s_add_u32 s33, s33, 1
    s_cmp_lt_u32 s33, 0x40000
    s_cbranch_scc1 L_sslow_15_l
    s_branch L_sdone_16
L_slow_17x:
    s_mov_b64 vcc, 1
L_slow_17:
    s_mov_b32 s33, 0
L_slow_17_l:
    s_mov_b64 exec, vcc
    s_sleep 1
    v_mov_b32 v7, 0
    buffer_atomic_add v7, v252, s[12:15], s42 offen sc0
    s_waitcnt vmcnt(0)
    v_cmp_ne_u32 vcc, s47, v7
    s_mov_b64 exec, -1
    s_cbranch_vccz L_pdone_18
    s_add_u32 s33, s33, 1
    s_cmp_lt_u32 s33, 0x40000
    s_cbranch_scc1 L_slow_17_l
    s_branch L_pdone_18
L_slow_19x:
    s_mov_b64 vcc, 1
L_slow_19:
    s_mov_b32 s33, 0
L_slow_19_l:
    s_mov_b64 exec, vcc
    s_sleep 1
    v_mov_b32 v7, 0
    buffer_atomic_add v7, v252, s[12:15], s42 offen sc0
    s_waitcnt vmcnt(0)
    v_cmp_ne_u32 vcc, s47, v7
    s_mov_b64 exec, -1
    s_cbranch_vccz L_pdone_20
    s_add_u32 s33, s33, 1
    s_cmp_lt_u32 s33, 0x40000
    s_cbranch_scc1 L_slow_19_l
    s_branch L_pdone_20
L_slow_21x:
    s_waitcnt vmcnt(6)
    v_cmp_ne_u32 vcc, s47, v23
    s_and_b64 vcc, vcc, 1
    s_cbranch_scc0 L_pdone_22
    s_mov_b64 vcc, 1
L_slow_21:
    s_mov_b32 s33, 0
L_slow_21_l:
    s_mov_b64 exec, vcc
    s_sleep 1
    v_mov_b32 v7, 0
    buffer_atomic_add v7, v252, s[12:15], s42 offen sc0
    s_waitcnt vmcnt(0)
    v_cmp_ne_u32 vcc, s47, v7
    s_mov_b64 exec, -1
    s_cbranch_vccz L_pdone_22
    s_add_u32 s33, s33, 1
    s_cmp_lt_u32 s33, 0x40000
    s_cbranch_scc1 L_slow_21_l
    s_branch L_pdone_22
L_slow_23x:
    s_waitcnt vmcnt(6)
    v_cmp_ne_u32 vcc, s47, v23
    s_and_b64 vcc, vcc, 1
    s_cbranch_scc0 L_pdone_24
    s_mov_b64 vcc, 1
L_slow_23:
    s_mov_b32 s33, 0
L_slow_23_l:
    s_mov_b64 exec, vcc
    s_sleep 1
    v_mov_b32_e64 v7, 0
    buffer_atomic_add v7, v252, s[12:15], s42 offen sc0
    s_waitcnt vmcnt(0)
    v_cmp_ne_u32 vcc, s47, v7
    s_mov_b64 exec, -1
    s_cbranch_vccz L_pdone_24
    s_add_u32 s33, s33, 1
    s_cmp_lt_u32 s33, 0x40000
    s_cbranch_scc1 L_slow_23_l
    s_branch L_pdone_24
L_spare:
    s_barrier
    s_and_b32 s5, s2, 6
    s_lshl_b32 s5, s5, 1
    s_bfe_u32 s6, s2, 0x20003
    s_add_u32 s66, s5, s6
    s_lshr_b32 s5, s66, 2
    s_lshl2_add_u32 s5, s68, s5
    s_lshl3_add_u32 s5, s5, s6
    s_lshl2_add_u32 s5, s5, s4
    s_lshl_b32 s5, s5, 8
    s_add_u32 s40, s5, 524288
    s_mul_i32 s6, s4, 56
    v_mov_b32 v2, 7
    v_and_b32 v4, 60, v1
    v_lshlrev_b32 v4, 25, v4
    v_lshl_add_u32 v8, v1, 8, v4
    v_lshrrev_b32 v5, 4, v1
    v_and_b32 v6, 15, v1
    v_mul_u32_u24 v4, 4352, v5
    v_lshl_add_u32 v4, v6, 4, v4
    s_mul_i32 s6, s6, 4352
    s_lshl_b32 s5, s66, 8
    s_add_u32 s5, s5, s6
    s_mul_i32 s6, s68, 974848
    s_add_u32 s5, s5, s6
    s_add_u32 s5, s5, 4521984
    v_add_u32 v11, s5, v4
    v_lshl_add_u32 v4, v6, 2, v5
    s_lshl_b32 s5, s4, 9
    v_lshl_add_u32 v12, v4, 3, s5
    v_lshlrev_b32 v13, 3, v1
    v_mov_b32 v14, 0x3f803f80
    s_sub_u32 s6, s2, 224
    s_lshr_b32 s5, s4, 1
    s_lshl1_add_u32 s6, s6, s5
    s_mul_i32 s6, s6, 4480
    s_add_u32 s6, s6, 458752
    v_min_u32_e64 v4, 34, v1
    v_lshl_add_u32 v4, v4, 7, s6
    s_mul_i32 s5, s68, 286720
    s_mul_i32 s6, s68, 8960
    global_load_dword v56, v4, s[88:89]
    v_add_u32 v4, 286720, v4
    global_load_dword v57, v4, s[88:89]
    v_add_u32 v4, 286720, v4
    global_load_dword v58, v4, s[88:89]
    v_add_u32 v4, 286720, v4
    global_load_dword v59, v4, s[88:89]
    s_sub_u32 s6, s2, 224
    s_cmp_ge_u32 s6, 28
    s_cbranch_scc1 L_sp_nowf
    s_lshr_b32 s69, s6, 2
    s_and_b32 s7, s6, 3
    s_lshl_b32 s82, s6, 10
    s_add_u32 s82, s82, 753664
    s_mul_i32 s6, s6, 57344
    s_add_u32 s6, s6, 13811712
    v_add_u32 v20, s6, v3
    v_lshrrev_b32 v6, 3, v1
    v_and_b32 v7, 6, v6
    v_and_b32 v5, 7, v1
    v_xor_b32 v7, v7, v5
    v_mul_u32_u24 v6, 896, v6
    v_lshl_add_u32 v6, v7, 4, v6
    s_mul_i32 s5, s7, 401408
    s_lshl_b32 s6, s69, 7
    s_add_u32 s5, s5, s6
    v_add_u32_e64 v48, s5, v6
    v_add_u32 v49, 6144, v48
    v_add_u32 v50, 12288, v48
    v_add_u32 v51, 18432, v48
    s_lshl_b32 s89, s4, 14
    s_addk_i32 s89, 4096
    s_lshl2_add_u32 s36, s4, 0
    s_min_u32 s36, s36, 13
    s_mul_i32 s79, s36, 28672
    s_add_u32 m0, s89, 0
    s_lshl_b32 s36, s36, 12
    buffer_load_dwordx4 v48, s[24:27], s79 offen lds
    buffer_load_dwordx4 v49, s[24:27], s79 offen offset:1024 lds
    buffer_load_dwordx4 v50, s[24:27], s79 offen offset:2048 lds
    buffer_load_dwordx4 v51, s[24:27], s79 offen offset:3072 lds
    s_lshl2_add_u32 s37, s4, 1
    s_min_u32 s37, s37, 13
    s_mul_i32 s79, s37, 28672
    s_add_u32 m0, s89, 4096
    s_lshl_b32 s37, s37, 12
    buffer_load_dwordx4 v48, s[24:27], s79 offen lds
    buffer_load_dwordx4 v49, s[24:27], s79 offen offset:1024 lds
    buffer_load_dwordx4 v50, s[24:27], s79 offen offset:2048 lds
    buffer_load_dwordx4 v51, s[24:27], s79 offen offset:3072 lds
    s_lshl2_add_u32 s38, s4, 2
    s_min_u32 s38, s38, 13
    s_mul_i32 s79, s38, 28672
    s_add_u32 m0, s89, 8192
    s_lshl_b32 s38, s38, 12
    buffer_load_dwordx4 v48, s[24:27], s79 offen lds
    buffer_load_dwordx4 v49, s[24:27], s79 offen offset:1024 lds
    buffer_load_dwordx4 v50, s[24:27], s79 offen offset:2048 lds
    buffer_load_dwordx4 v51, s[24:27], s79 offen offset:3072 lds
    s_lshl2_add_u32 s39, s4, 3
    s_min_u32 s39, s39, 13
    s_mul_i32 s79, s39, 28672
    s_add_u32 m0, s89, 12288
    s_lshl_b32 s39, s39, 12
    buffer_load_dwordx4 v48, s[24:27], s79 offen lds
    buffer_load_dwordx4 v49, s[24:27], s79 offen offset:1024 lds
    buffer_load_dwordx4 v50, s[24:27], s79 offen offset:2048 lds
    buffer_load_dwordx4 v51, s[24:27], s79 offen offset:3072 lds
    v_lshrrev_b32 v4, 4, v1
    v_lshrrev_b32 v6, 1, v4
    v_lshlrev_b32 v6, 4, v6
    v_and_b32_e64 v7, 1, v4
    v_lshl_add_u32 v6, v7, 2, v6
    v_bfe_u32 v7, v1, 2, 2
    v_add_u32_e64 v6, v6, v7
    v_bfe_u32 v7, v6, 1, 2
    v_lshlrev_b32 v6, 7, v6
    v_and_b32 v5, 3, v1
    v_lshl_add_u32 v6, v5, 3, v6
    v_xor_b32_e64 v5, 0, v7
    v_lshl_add_u32 v5, v5, 5, v6
    v_add_u32 v52, s89, v5
    v_xor_b32 v5, 1, v7
    v_lshl_add_u32 v5, v5, 5, v6
    v_add_u32 v53, s89, v5
    v_xor_b32 v5, 2, v7
    v_lshl_add_u32 v5, v5, 5, v6
    v_add_u32 v54, s89, v5
    v_xor_b32 v5, 3, v7
    v_lshl_add_u32 v5, v5, 5, v6
    v_add_u32 v55, s89, v5
    s_waitcnt vmcnt(12)
    ds_read_b64_tr_b16 v[64:65], v52 offset:0
    ds_read_b64_tr_b16 v[66:67], v52 offset:1024
    ds_read_b64_tr_b16 v[68:69], v53 offset:0
    ds_read_b64_tr_b16 v[70:71], v53 offset:1024
    ds_read_b64_tr_b16 v[72:73], v54 offset:0
    ds_read_b64_tr_b16 v[74:75], v54 offset:1024
    ds_read_b64_tr_b16 v[76:77], v55 offset:0
    ds_read_b64_tr_b16 v[78:79], v55 offset:1024
    s_waitcnt lgkmcnt(6)
    buffer_store_dwordx4 v[64:67], v20, s[12:15], s36 offen offset:0 sc1
    s_waitcnt lgkmcnt(4)
    buffer_store_dwordx4 v[68:71], v20, s[12:15], s36 offen offset:1024 sc1
    s_waitcnt lgkmcnt(2)
    buffer_store_dwordx4 v[72:75], v20, s[12:15], s36 offen offset:2048 sc1
    s_waitcnt lgkmcnt(0)
    buffer_store_dwordx4 v[76:79], v20, s[12:15], s36 offen offset:3072 sc1
    s_waitcnt vmcnt(12)
    ds_read_b64_tr_b16 v[80:81], v52 offset:4096
    ds_read_b64_tr_b16 v[82:83], v52 offset:5120
    ds_read_b64_tr_b16 v[84:85], v53 offset:4096
    ds_read_b64_tr_b16 v[86:87], v53 offset:5120
    ds_read_b64_tr_b16 v[88:89], v54 offset:4096
    ds_read_b64_tr_b16 v[90:91], v54 offset:5120
    ds_read_b64_tr_b16 v[92:93], v55 offset:4096
    ds_read_b64_tr_b16 v[94:95], v55 offset:5120
    s_waitcnt lgkmcnt(6)
    buffer_store_dwordx4 v[80:83], v20, s[12:15], s37 offen offset:0 sc1
    s_waitcnt lgkmcnt(4)
    buffer_store_dwordx4 v[84:87], v20, s[12:15], s37 offen offset:1024 sc1
    s_waitcnt lgkmcnt(2)
    buffer_store_dwordx4 v[88:91], v20, s[12:15], s37 offen offset:2048 sc1
    s_waitcnt lgkmcnt(0)
    buffer_store_dwordx4 v[92:95], v20, s[12:15], s37 offen offset:3072 sc1
    s_waitcnt vmcnt(12)
    ds_read_b64_tr_b16 v[96:97], v52 offset:8192
    ds_read_b64_tr_b16 v[98:99], v52 offset:9216
    ds_read_b64_tr_b16 v[100:101], v53 offset:8192
    ds_read_b64_tr_b16 v[102:103], v53 offset:9216
    ds_read_b64_tr_b16 v[104:105], v54 offset:8192
    ds_read_b64_tr_b16 v[106:107], v54 offset:9216
    ds_read_b64_tr_b16 v[108:109], v55 offset:8192
    ds_read_b64_tr_b16 v[110:111], v55 offset:9216
    s_waitcnt lgkmcnt(6)
    buffer_store_dwordx4 v[96:99], v20, s[12:15], s38 offen offset:0 sc1
    s_waitcnt lgkmcnt(4)
    buffer_store_dwordx4 v[100:103], v20, s[12:15], s38 offen offset:1024 sc1
    s_waitcnt lgkmcnt(2)
    buffer_store_dwordx4 v[104:107], v20, s[12:15], s38 offen offset:2048 sc1
    s_waitcnt lgkmcnt(0)
    buffer_store_dwordx4 v[108:111], v20, s[12:15], s38 offen offset:3072 sc1
    s_waitcnt vmcnt(12)
    ds_read_b64_tr_b16 v[112:113], v52 offset:12288
    ds_read_b64_tr_b16 v[114:115], v52 offset:13312
    ds_read_b64_tr_b16 v[116:117], v53 offset:12288
    ds_read_b64_tr_b16 v[118:119], v53 offset:13312
    ds_read_b64_tr_b16 v[120:121], v54 offset:12288
    ds_read_b64_tr_b16 v[122:123], v54 offset:13312
    ds_read_b64_tr_b16 v[124:125], v55 offset:12288
    ds_read_b64_tr_b16 v[126:127], v55 offset:13312
    s_waitcnt lgkmcnt(6)
    buffer_store_dwordx4 v[112:115], v20, s[12:15], s39 offen offset:0 sc1
    s_waitcnt lgkmcnt(4)
    buffer_store_dwordx4 v[116:119], v20, s[12:15], s39 offen offset:1024 sc1
    s_waitcnt lgkmcnt(2)
    buffer_store_dwordx4 v[120:123], v20, s[12:15], s39 offen offset:2048 sc1
    s_waitcnt lgkmcnt(0)
    buffer_store_dwordx4 v[124:127], v20, s[12:15], s39 offen offset:3072 sc1
    s_waitcnt vmcnt(0)
    buffer_atomic_add v2, v8, s[12:15], s82 offen
L_sp_nowf:
    s_mov_b64 vcc, 3
L_sp_c:
    s_mov_b32 s33, 0
L_sp_c_l:
    s_mov_b64 exec, vcc
    s_sleep 2
    v_mov_b32_e64 v7, 0
    buffer_atomic_add v7, v43, s[12:15], s40 offen sc0
    s_waitcnt vmcnt(0)
    v_cmp_ne_u32 vcc, s46, v7
    s_mov_b64 exec, -1
    s_cbranch_vccz L_sp_d
    s_add_u32 s33, s33, 1
    s_cmp_lt_u32 s33, 0x40000
    s_cbranch_scc1 L_sp_c_l
    s_branch L_sp_d
L_sp_d:
    s_mov_b32 s5, 0
    buffer_load_dwordx4 v[64:67], v11, s[12:15], s5 offen sc1
    s_mov_b32 s5, 17408
    buffer_load_dwordx4 v[68:71], v11, s[12:15], s5 offen sc1
    s_mov_b32 s5, 34816
    buffer_load_dwordx4 v[72:75], v11, s[12:15], s5 offen sc1
    s_mov_b32 s5, 52224
    buffer_load_dwordx4 v[76:79], v11, s[12:15], s5 offen sc1
    s_mov_b32 s5, 69632
    buffer_load_dwordx4 v[80:83], v11, s[12:15], s5 offen sc1
    s_mov_b32 s5, 87040
    buffer_load_dwordx4 v[84:87], v11, s[12:15], s5 offen sc1
    s_mov_b32 s5, 104448
    buffer_load_dwordx4 v[88:91], v11, s[12:15], s5 offen sc1
    s_mov_b32 s5, 121856
    buffer_load_dwordx4 v[92:95], v11, s[12:15], s5 offen sc1
    s_mov_b32 s5, 139264
    buffer_load_dwordx4 v[96:99], v11, s[12:15], s5 offen sc1
    s_mov_b32 s5, 156672
    buffer_load_dwordx4 v[100:103], v11, s[12:15], s5 offen sc1
    s_mov_b32 s5, 174080
    buffer_load_dwordx4 v[104:107], v11, s[12:15], s5 offen sc1
    s_mov_b32 s5, 191488
    buffer_load_dwordx4 v[108:111], v11, s[12:15], s5 offen sc1
    s_mov_b32 s5, 208896
    buffer_load_dwordx4 v[112:115], v11, s[12:15], s5 offen sc1
    s_mov_b32 s5, 226304
    buffer_load_dwordx4 v[116:119], v11, s[12:15], s5 offen sc1
    v_mov_b32 v16, 0
    v_mov_b32 v17, 0
    v_mov_b32 v18, 0
    v_mov_b32 v19, 0
    v_mov_b32 v20, 0
    v_mov_b32 v21, 0
    v_mov_b32 v22, 0
    v_mov_b32 v23, 0
    s_waitcnt vmcnt(13)
    v_dot2c_f32_bf16 v16, v64, v14
    v_dot2c_f32_bf16 v17, v65, v14
    v_dot2c_f32_bf16 v18, v66, v14
    v_dot2c_f32_bf16 v19, v67, v14
    v_dot2c_f32_bf16 v20, v64, v64
    v_dot2c_f32_bf16 v21, v65, v65
    v_dot2c_f32_bf16 v22, v66, v66
    v_dot2c_f32_bf16 v23, v67, v67
    s_waitcnt vmcnt(12)
    v_dot2c_f32_bf16 v16, v68, v14
    v_dot2c_f32_bf16 v17, v69, v14
    v_dot2c_f32_bf16 v18, v70, v14
    v_dot2c_f32_bf16 v19, v71, v14
    v_dot2c_f32_bf16 v20, v68, v68
    v_dot2c_f32_bf16 v21, v69, v69
    v_dot2c_f32_bf16 v22, v70, v70
    v_dot2c_f32_bf16 v23, v71, v71
    s_waitcnt vmcnt(11)
    v_dot2c_f32_bf16 v16, v72, v14
    v_dot2c_f32_bf16 v17, v73, v14
    v_dot2c_f32_bf16 v18, v74, v14
    v_dot2c_f32_bf16 v19, v75, v14
    v_dot2c_f32_bf16 v20, v72, v72
    v_dot2c_f32_bf16 v21, v73, v73
    v_dot2c_f32_bf16 v22, v74, v74
    v_dot2c_f32_bf16 v23, v75, v75
    s_waitcnt vmcnt(10)
    v_dot2c_f32_bf16 v16, v76, v14
    v_dot2c_f32_bf16 v17, v77, v14
    v_dot2c_f32_bf16 v18, v78, v14
    v_dot2c_f32_bf16 v19, v79, v14
    v_dot2c_f32_bf16 v20, v76, v76
    v_dot2c_f32_bf16 v21, v77, v77
    v_dot2c_f32_bf16 v22, v78, v78
    v_dot2c_f32_bf16 v23, v79, v79
    s_waitcnt vmcnt(9)
    v_dot2c_f32_bf16 v16, v80, v14
    v_dot2c_f32_bf16 v17, v81, v14
    v_dot2c_f32_bf16 v18, v82, v14
    v_dot2c_f32_bf16 v19, v83, v14
    v_dot2c_f32_bf16 v20, v80, v80
    v_dot2c_f32_bf16 v21, v81, v81
    v_dot2c_f32_bf16 v22, v82, v82
    v_dot2c_f32_bf16 v23, v83, v83
    s_waitcnt vmcnt(8)
    v_dot2c_f32_bf16 v16, v84, v14
    v_dot2c_f32_bf16 v17, v85, v14
    v_dot2c_f32_bf16 v18, v86, v14
    v_dot2c_f32_bf16 v19, v87, v14
    v_dot2c_f32_bf16 v20, v84, v84
    v_dot2c_f32_bf16 v21, v85, v85
    v_dot2c_f32_bf16 v22, v86, v86
    v_dot2c_f32_bf16 v23, v87, v87
    s_waitcnt vmcnt(7)
    v_dot2c_f32_bf16 v16, v88, v14
    v_dot2c_f32_bf16 v17, v89, v14
    v_dot2c_f32_bf16 v18, v90, v14
    v_dot2c_f32_bf16 v19, v91, v14
    v_dot2c_f32_bf16 v20, v88, v88
    v_dot2c_f32_bf16 v21, v89, v89
    v_dot2c_f32_bf16 v22, v90, v90
    v_dot2c_f32_bf16 v23, v91, v91
    s_waitcnt vmcnt(6)
    v_dot2c_f32_bf16 v16, v92, v14
    v_dot2c_f32_bf16 v17, v93, v14
    v_dot2c_f32_bf16 v18, v94, v14
    v_dot2c_f32_bf16 v19, v95, v14
    v_dot2c_f32_bf16 v20, v92, v92
    v_dot2c_f32_bf16 v21, v93, v93
    v_dot2c_f32_bf16 v22, v94, v94
    v_dot2c_f32_bf16 v23, v95, v95
    s_waitcnt vmcnt(5)
    v_dot2c_f32_bf16 v16, v96, v14
    v_dot2c_f32_bf16 v17, v97, v14
    v_dot2c_f32_bf16 v18, v98, v14
    v_dot2c_f32_bf16 v19, v99, v14
    v_dot2c_f32_bf16 v20, v96, v96
    v_dot2c_f32_bf16 v21, v97, v97
    v_dot2c_f32_bf16 v22, v98, v98
    v_dot2c_f32_bf16 v23, v99, v99
    s_waitcnt vmcnt(4)
    v_dot2c_f32_bf16 v16, v100, v14
    v_dot2c_f32_bf16 v17, v101, v14
    v_dot2c_f32_bf16 v18, v102, v14
    v_dot2c_f32_bf16 v19, v103, v14
    v_dot2c_f32_bf16 v20, v100, v100
    v_dot2c_f32_bf16 v21, v101, v101
    v_dot2c_f32_bf16 v22, v102, v102
    v_dot2c_f32_bf16 v23, v103, v103
    s_waitcnt vmcnt(3)
    v_dot2c_f32_bf16 v16, v104, v14
    v_dot2c_f32_bf16 v17, v105, v14
    v_dot2c_f32_bf16 v18, v106, v14
    v_dot2c_f32_bf16 v19, v107, v14
    v_dot2c_f32_bf16 v20, v104, v104
    v_dot2c_f32_bf16 v21, v105, v105
    v_dot2c_f32_bf16 v22, v106, v106
    v_dot2c_f32_bf16 v23, v107, v107
    s_waitcnt vmcnt(2)
    v_dot2c_f32_bf16 v16, v108, v14
    v_dot2c_f32_bf16 v17, v109, v14
    v_dot2c_f32_bf16 v18, v110, v14
    v_dot2c_f32_bf16 v19, v111, v14
    v_dot2c_f32_bf16 v20, v108, v108
    v_dot2c_f32_bf16 v21, v109, v109
    v_dot2c_f32_bf16 v22, v110, v110
    v_dot2c_f32_bf16 v23, v111, v111
    s_waitcnt vmcnt(1)
    v_dot2c_f32_bf16 v16, v112, v14
    v_dot2c_f32_bf16 v17, v113, v14
    v_dot2c_f32_bf16 v18, v114, v14
    v_dot2c_f32_bf16 v19, v115, v14
    v_dot2c_f32_bf16 v20, v112, v112
    v_dot2c_f32_bf16 v21, v113, v113
    v_dot2c_f32_bf16 v22, v114, v114
    v_dot2c_f32_bf16 v23, v115, v115
    s_waitcnt vmcnt(0)
    v_dot2c_f32_bf16 v16, v116, v14
    v_dot2c_f32_bf16 v17, v117, v14
    v_dot2c_f32_bf16 v18, v118, v14
    v_dot2c_f32_bf16 v19, v119, v14
    v_dot2c_f32_bf16 v20, v116, v116
    v_dot2c_f32_bf16 v21, v117, v117
    v_dot2c_f32_bf16 v22, v118, v118
    v_dot2c_f32_bf16 v23, v119, v119
    v_permlane32_swap_b32 v16, v18
    v_permlane32_swap_b32 v17, v19
    v_permlane32_swap_b32 v20, v22
    v_permlane32_swap_b32 v21, v23
    v_add_f32 v16, v16, v18
    v_add_f32 v17, v17, v19
    v_add_f32 v20, v20, v22
    v_add_f32 v21, v21, v23
    v_permlane16_swap_b32 v16, v17
    s_nop 0
    v_permlane16_swap_b32 v20, v21
    v_add_f32 v16, v16, v17
    v_add_f32_e64 v17, v20, v21
    ds_write_b64 v12, v[16:17]
    s_waitcnt lgkmcnt(0)
    s_barrier
    s_cmp_lg_u32 s4, 0
    s_cbranch_scc1 L_fin
    ds_read_b64 v[24:25], v13 offset:0
    ds_read_b64 v[26:27], v13 offset:512
    ds_read_b64 v[28:29], v13 offset:1024
    ds_read_b64 v[30:31], v13 offset:1536
    s_lshl_b32 s5, s66, 1
    s_add_u32 s5, s5, s68
    s_lshl_b32 s5, s5, 9
    s_add_u32 s5, s5, 360448
    s_waitcnt lgkmcnt(2)
    v_pk_add_f32 v[24:25], v[24:25], v[26:27]
    s_waitcnt lgkmcnt(0)
    v_pk_add_f32 v[28:29], v[28:29], v[30:31]
    v_pk_add_f32 v[24:25], v[24:25], v[28:29]
    v_mul_f32 v24, s80, v24
    v_mul_f32_e64 v25, s80, v25
    v_fma_f32 v25, -v24, v24, v25
    v_max_f32_e64 v25, 0, v25
    v_add_f32 v25, 0x3727c5ac, v25
    v_rsq_f32_e64 v25, v25
    v_cvt_pk_bf16_f32 v24, 0, -v24
    v_cvt_f16_f32_e64 v25, v25
    v_and_b32 v25, 0xffff, v25
    v_or_b32 v24, v24, v25
    v_mov_b32 v25, s32
    buffer_store_dwordx2 v[24:25], v13, s[12:15], s5 offen sc1
    s_add_u32 s5, s5, 20480
    buffer_store_dwordx2 v[24:25], v13, s[12:15], s5 offen sc1
    s_add_u32 s5, s5, 20480
    buffer_store_dwordx2 v[24:25], v13, s[12:15], s5 offen sc1
    s_add_u32 s5, s5, 20480
    buffer_store_dwordx2 v[24:25], v13, s[12:15], s5 offen sc1
    s_add_u32 s5, s5, 20480
    buffer_store_dwordx2 v[24:25], v13, s[12:15], s5 offen sc1
    s_add_u32 s5, s5, 20480
    buffer_store_dwordx2 v[24:25], v13, s[12:15], s5 offen sc1
    s_add_u32 s5, s5, 20480
    buffer_store_dwordx2 v[24:25], v13, s[12:15], s5 offen sc1
    s_add_u32 s5, s5, 20480
    s_cmp_lg_u32 s2, 255
    s_cbranch_scc1 L_fin
    v_lshlrev_b32 v4, 25, v1
    buffer_store_dword v25, v4, s[12:15], 0 offen sc1
    s_branch L_fin
.set L_early0, L_pad0
.set L_early1, L_pad1
.set L_early2, L_pad2
.set L_early3, L_early_back
.set L_walk0, L_pad3
.set L_walk1, L_pad4
.set L_walk2, L_pad5
.set L_walk3, L_walk_back
.p2align 8
.fill 64, 4, 0xbf800000
L_codeend:
.section .rodata,"a"
.p2align 6
.amdhsa_kernel sequential_preLN__ssm_conv_s4d__geglu_ffn__prompt_kernel
  .amdhsa_next_free_vgpr 512
  .amdhsa_next_free_sgpr 102
  .amdhsa_accum_offset 256
  .amdhsa_group_segment_fixed_size 0
  .amdhsa_kernarg_size 112
  .amdhsa_user_sgpr_count 2
  .amdhsa_user_sgpr_kernarg_segment_ptr 1
  .amdhsa_system_sgpr_workgroup_id_x 1
.end_amdhsa_kernel
```
